```python
import torch

def _softmax(x, axis=-1):
    return torch.softmax(x, dim=axis)
def _gelu(x):
    return torch.nn.functional.gelu(x, approximate="tanh")
def _silu(x):
    return torch.nn.functional.silu(x)
def _sigmoid(x):
    return torch.sigmoid(x)
def _layernorm(x, axis=-1, eps=1e-5):
    m = x.mean(dim=axis, keepdim=True)
    v = x.var(dim=axis, keepdim=True, unbiased=False)
    return (x - m) / torch.sqrt(v + eps)
def _scatter_add(tgt, idx, src, axis=0):
    return tgt.clone().index_add_(axis, idx, src)
def _segment_sum(src, seg, n):
    out = torch.zeros((n,) + src.shape[1:], dtype=src.dtype)
    return out.index_add_(0, seg, src)
def _pad(x, pw):
    flat = tuple(v for pair in reversed(pw) for v in pair)
    return torch.nn.functional.pad(x, flat)

kernel_name = 'sequential_preLN__sliding_block_cached__glu_gated_glu__decode'

def setup_inputs():

    _w = (lambda a: (lambda t: t.to(torch.bfloat16) if t.is_floating_point() else t)(torch.as_tensor(a)))
    def _A_setup():
        B, Sq, D = 8, 1, 640
        Hq, Hkv, Sk, Dh = 32, 32, 4096, 128
        assert Hq % Hkv == 0, (Hq, Hkv)
        return {
            "x": _w((lambda *s: torch.randn(*s, dtype=torch.bfloat16) * 0.05)(B, Sq, D)),
            "k_cache": _w((lambda *s: torch.randn(*s, dtype=torch.bfloat16) * 3.2)(B, Hkv, Sk, Dh)),
            "v_cache": _w((lambda *s: torch.randn(*s, dtype=torch.bfloat16) * 0.4)(B, Hkv, Sk, Dh)),
            "wq": _w((lambda *s: torch.randn(*s, dtype=torch.bfloat16) * 3.2)(D, Hq * Dh) * (D ** -0.5)),
            "wo": _w((lambda *s: torch.randn(*s, dtype=torch.bfloat16) * 0.4)(Hq * Dh, D) * ((Hq * Dh) ** -0.5)),
        }
    _A_in = _A_setup()

    def _B_setup():
        B, S, D, F = 8, 1, 640, 1728
        return {
            "x": _w((lambda *s: torch.randn(*s, dtype=torch.bfloat16) * 0.05)(B, S, D)),
            "w_gate": _w((lambda *s: torch.randn(*s, dtype=torch.bfloat16) * 0.1)(D, F)),
            "w_up": _w((lambda *s: torch.randn(*s, dtype=torch.bfloat16) * 0.05)(D, F)),
            "w_down": _w((lambda *s: torch.randn(*s, dtype=torch.bfloat16) * 0.05)(F, D)),
        }
    _B_in = _B_setup()

    return {
        "A_x": _A_in["x"],
        "A_k_cache": _A_in["k_cache"],
        "A_v_cache": _A_in["v_cache"],
        "A_wq": _A_in["wq"],
        "A_wo": _A_in["wo"],
        "B_x": _B_in["x"],
        "B_w_gate": _B_in["w_gate"],
        "B_w_up": _B_in["w_up"],
        "B_w_down": _B_in["w_down"],
    }

def reference(A_x, A_k_cache, A_v_cache, A_wq, A_wo, B_x, B_w_gate, B_w_up, B_w_down):
    def _A_ref(x, k_cache, v_cache, wq, wo):
        B, Sq, D = x.shape
        Hq, Dh = 32, 128
        Hkv, Sk = k_cache.shape[1], k_cache.shape[2]
        W = min(4096, max(256, Sk // 4))
        rep = Hq // Hkv
        q = (lambda x, *d: x.permute(*d))((x @ wq).reshape(B, Sq, Hq, Dh), 0, 2, 1, 3)
        k = (lambda x, n, axis: torch.repeat_interleave(x, n, dim=axis))(k_cache[:, :, Sk - W:, :], rep, axis=1)
        v = (lambda x, n, axis: torch.repeat_interleave(x, n, dim=axis))(v_cache[:, :, Sk - W:, :], rep, axis=1)
        scores = torch.einsum("bhqd,bhkd->bhqk", q, k) * (Dh ** -0.5)
        p = _softmax(scores, axis=-1)
        o = torch.einsum("bhqk,bhkd->bhqd", p, v)
        return (lambda x, *d: x.permute(*d))(o, 0, 2, 1, 3).reshape(B, Sq, Hq * Dh) @ wo

    def _B_ref(x, w_gate, w_up, w_down):
        g = torch.einsum("bsd,df->bsf", x, w_gate)
        u = torch.einsum("bsd,df->bsf", x, w_up)
        h = _sigmoid(g) * u
        return torch.einsum("bsf,fd->bsd", h, w_down)

    x = A_x
    h = x + _A_ref(_layernorm(x, axis=-1), A_k_cache, A_v_cache, A_wq, A_wo)
    h2 = h + _B_ref(_layernorm(h, axis=-1), B_w_gate, B_w_up, B_w_down)
    return h2
```

```asm
; @launch grid=(256,1,1) block=(256,1,1) lds=120576
.amdgcn_target "amdgcn-amd-amdhsa--gfx950"
.text
.globl sequential_preLN__sliding_block_cached__glu_gated_glu__decode_kernel
.p2align 8
.type sequential_preLN__sliding_block_cached__glu_gated_glu__decode_kernel,@function
sequential_preLN__sliding_block_cached__glu_gated_glu__decode_kernel:
  s_load_dwordx16 s[40:55], s[0:1], 0
  s_load_dwordx8 s[56:63], s[0:1], 64
  s_cmpk_ge_u32 s2, 0x100
  s_cbranch_scc1 L_end
  v_and_b32 v2, 3, v0
  v_lshlrev_b32 v2, 4, v2
  v_and_b32 v52, 12, v0
  v_lshl_or_b32 v2, v52, 6, v2
  v_and_b32 v52, 48, v0
  v_lshl_or_b32 v2, v52, 2, v2
  v_lshrrev_b32 v6, 6, v0
  v_lshl_or_b32 v2, v6, 13, v2
  s_and_b32 s66, s2, 0xe4
  s_and_b32 s4, s2, 3
  s_lshl3_add_u32 s66, s4, s66
  s_bfe_u32 s4, s2, 0x20003
  s_add_u32 s66, s66, s4
  s_lshl2_add_u32 s6, s66, 3
  s_lshl_b32 s6, s6, 18
  s_lshl_b32 s10, 1, 18
  s_mov_b32 s11, 0x20000
  s_movk_i32 s65, 0x1000
  s_waitcnt lgkmcnt(0)
  s_add_u32 s8, s42, s6
  s_addc_u32 s9, s43, 0
  buffer_load_dwordx4 a[0:3], v2, s[8:11], 0 offen offset:0 nt
  buffer_load_dwordx4 a[4:7], v2, s[8:11], 0 offen offset:1024 nt
  buffer_load_dwordx4 a[8:11], v2, s[8:11], 0 offen offset:2048 nt
  buffer_load_dwordx4 a[12:15], v2, s[8:11], 0 offen offset:3072 nt
  v_readfirstlane_b32 s3, v6
  v_bfe_u32 v7, v0, 4, 2
  v_lshlrev_b32 v63, 13, v6
  s_and_b32 s4, s66, 31
  s_lshr_b32 s5, s2, 5
  s_lshl_b32 s66, s66, 12
  s_mov_b32 s100, 0
  s_mov_b32 s24, s40
  s_mov_b32 s25, s41
  s_mov_b32 s26, 10240
  s_mov_b32 s27, 0x20000
  v_lshrrev_b32 v54, 5, v0
  v_and_b32 v55, 31, v0
  v_mul_u32_u24 v92, 1280, v54
  v_lshl_add_u32 v93, v55, 3, v92
  v_lshl_add_u32 v92, v55, 4, v92
  v_and_b32 v15, 15, v0
  v_mul_u32_u24 v52, 20, v6
  v_add_u32 v52, v52, v7
  v_lshlrev_b32 v53, 4, v15
  v_lshl_add_u32 v4, v52, 13, v53
  s_and_b32 s7, s5, 7
  s_mul_i32 s7, s7, 655360
  s_lshl_b32 s65, s4, 8
  s_add_u32 s7, s7, s65
  s_sub_u32 s18, 5242880, s7
  s_mov_b32 s19, 0x20000
  s_add_u32 s16, s46, s7
  s_addc_u32 s17, s47, 0
  buffer_load_dwordx4 v[176:179], v92, s[24:27], 0 offen
  buffer_load_dwordx4 v[180:183], v92, s[24:27], 0 offen offset:512
  buffer_load_dwordx2 v[184:185], v93, s[24:27], 0 offen offset:1024
  s_mov_b32 s65, 0
  buffer_load_dwordx4 v[188:191], v4, s[16:19], s65 offen nt
  s_mov_b32 s65, 4096
  buffer_load_dwordx4 a[16:19], v2, s[8:11], s65 offen nt
  s_mov_b32 s65, 32768
  buffer_load_dwordx4 v[192:195], v4, s[16:19], s65 offen nt
  s_mov_b32 s65, 5120
  buffer_load_dwordx4 a[20:23], v2, s[8:11], s65 offen nt
  s_mov_b32 s65, 65536
  buffer_load_dwordx4 v[196:199], v4, s[16:19], s65 offen nt
  s_add_u32 s12, s44, s6
  s_addc_u32 s13, s45, 0
  s_mov_b32 s14, 0x40000
  s_mov_b32 s15, 0x20000
  s_mul_i32 s7, s4, 163840
  s_add_u32 s20, s48, s7
  s_addc_u32 s21, s49, 0
  s_mov_b32 s22, 163840
  s_mov_b32 s23, 0x20000
  s_mov_b32 s32, s20
  s_mov_b32 s33, s21
  s_mov_b32 s34, 163840
  s_mov_b32 s35, 0x20000
  s_mov_b32 s28, s62
  s_mov_b32 s29, s63
  s_mov_b32 s30, 1277952
  s_mov_b32 s31, 0x20000
  s_mov_b32 s36, s58
  s_mov_b32 s37, s59
  s_mov_b32 s38, 10240
  s_mov_b32 s39, 0x20000
  v_and_b32 v1, 63, v0
  v_lshlrev_b32 v3, 4, v0
  v_bfe_u32 v90, v0, 4, 1
  v_lshl_add_u32 v63, v90, 8, v63
  v_bfe_u32 v90, v0, 5, 1
  v_lshl_add_u32 v63, v90, 9, v63
  v_and_b32 v90, 15, v0
  v_lshl_add_u32 v63, v90, 4, v63
  v_lshlrev_b32 v90, 4, v1
  v_lshlrev_b32 v89, 2, v0
  v_lshl_add_u32 v54, v6, 5, v7
  v_mul_u32_u24 v54, 1280, v54
  v_add_u32 v5, v54, v53
  v_lshrrev_b32 v54, 5, v0
  v_lshl_add_u32 v13, v54, 6, v92
  v_lshl_add_u32 v94, v54, 6, v93
  v_bfe_u32 v54, v0, 3, 1
  v_mul_u32_u24 v54, 1344, v54
  s_and_b32 s7, s5, 7
  s_mul_i32 s7, s7, 80
  s_and_b32 s65, s5, 0
  s_mul_i32 s65, s65, 672
  s_add_u32 s7, s7, s65
  v_add_u32 v52, s7, v52
  v_lshl_add_u32 v14, v52, 1, v54
  buffer_load_dword v95, off, s[12:15], 0 nt
  buffer_load_dword v95, off, s[20:23], 0 nt
  v_and_b32 v52, 1, v0
  v_lshlrev_b32 v52, 4, v52
  v_mov_b32 v53, 0xffff
  v_lshlrev_b32 v52, v52, v53
  v_bfe_u32 v53, v0, 1, 2
  v_cmp_eq_u32 vcc, 0, v53
  s_nop 1
  v_cndmask_b32 v8, 0, v52, vcc
  v_cmp_eq_u32 vcc, 1, v53
  s_nop 1
  v_cndmask_b32 v9, 0, v52, vcc
  v_cmp_eq_u32 vcc, 2, v53
  s_nop 1
  v_cndmask_b32 v10, 0, v52, vcc
  v_cmp_eq_u32 vcc, 3, v53
  s_nop 1
  v_cndmask_b32 v11, 0, v52, vcc
  s_and_b32 s70, s2, 7
  s_lshr_b32 s71, s2, 3
  s_cmp_lt_u32 s70, 3
  s_cselect_b32 s72, 8, 6
  s_cmp_lt_u32 s71, s72
  s_cbranch_scc1 L_streamG
  v_bfe_u32 v53, v0, 3, 1
  s_lshl_b32 s7, s3, 1
  v_add_u32 v53, s7, v53
  v_lshlrev_b32 v53, 17, v53
  v_and_b32 v54, 7, v0
  v_lshl_add_u32 v54, v7, 3, v54
  v_lshl_add_u32 v74, v54, 4, v53
  s_lshl_b32 s7, s4, 12
  s_lshl_b32 s67, s5, 9
  s_add_u32 s67, s67, s7
  s_add_u32 s67, s67, 229376
  s_waitcnt vmcnt(11)
  s_mov_b32 s65, 6144
  buffer_load_dwordx4 a[24:27], v2, s[8:11], s65 offen nt
  s_waitcnt vmcnt(8)
  s_waitcnt vmcnt(7)
  s_mov_b32 s65, 98304
  buffer_load_dwordx4 v[200:203], v4, s[16:19], s65 offen nt
  s_waitcnt vmcnt(7)
  s_mov_b32 s65, 7168
  buffer_load_dwordx4 a[28:31], v2, s[8:11], s65 offen nt
  s_waitcnt vmcnt(7)
  s_mov_b32 s65, 131072
  buffer_load_dwordx4 v[204:207], v4, s[16:19], s65 offen nt
  s_waitcnt vmcnt(7)
  s_mov_b32 s65, 32768
  buffer_load_dwordx4 a[32:35], v2, s[8:11], s65 offen nt
  v_lshlrev_b32 v208, 16, v176
  v_and_b32 v209, 0xffff0000, v176
  v_lshlrev_b32 v210, 16, v177
  v_and_b32 v211, 0xffff0000, v177
  v_pk_add_f32 v[52:53], v[208:209], v[210:211]
  v_lshlrev_b32 v212, 16, v178
  v_and_b32 v213, 0xffff0000, v178
  v_pk_add_f32 v[52:53], v[52:53], v[212:213]
  v_lshlrev_b32 v214, 16, v179
  v_and_b32 v215, 0xffff0000, v179
  v_pk_add_f32 v[52:53], v[52:53], v[214:215]
  v_lshlrev_b32 v216, 16, v180
  v_and_b32 v217, 0xffff0000, v180
  v_pk_add_f32 v[52:53], v[52:53], v[216:217]
  v_lshlrev_b32 v218, 16, v181
  v_and_b32 v219, 0xffff0000, v181
  v_pk_add_f32 v[52:53], v[52:53], v[218:219]
  v_lshlrev_b32 v220, 16, v182
  v_and_b32 v221, 0xffff0000, v182
  v_pk_add_f32 v[52:53], v[52:53], v[220:221]
  v_lshlrev_b32 v222, 16, v183
  v_and_b32 v223, 0xffff0000, v183
  v_pk_add_f32 v[52:53], v[52:53], v[222:223]
  v_lshlrev_b32 v224, 16, v184
  v_and_b32 v225, 0xffff0000, v184
  v_pk_add_f32 v[52:53], v[52:53], v[224:225]
  v_lshlrev_b32 v226, 16, v185
  v_and_b32 v227, 0xffff0000, v185
  v_pk_add_f32 v[52:53], v[52:53], v[226:227]
  v_add_f32 v52, v52, v53
  s_nop 1
  v_add_f32_dpp v52, v52, v52 quad_perm:[1,0,3,2] row_mask:0xf bank_mask:0xf
  s_nop 1
  v_add_f32_dpp v52, v52, v52 quad_perm:[2,3,0,1] row_mask:0xf bank_mask:0xf
  s_nop 1
  v_add_f32_dpp v52, v52, v52 row_half_mirror row_mask:0xf bank_mask:0xf
  s_nop 1
  v_add_f32_dpp v52, v52, v52 row_mirror row_mask:0xf bank_mask:0xf
  v_mov_b32 v53, v52
  s_nop 1
  s_waitcnt vmcnt(7)
  s_mul_i32 s65, s5, 5120
  buffer_load_dwordx4 v[172:175], v5, s[32:35], s65 offen offset:0
  v_permlane16_swap_b32 v52, v53
  s_nop 0
  v_add_f32 v52, v52, v53
  v_mul_f32 v52, 0xbacccccd, v52
  v_cvt_pk_bf16_f32 v54, 0, v52
  v_pk_add_f32 v[56:57], v[208:209], v[52:53] op_sel_hi:[1,0]
  v_pk_mul_f32 v[58:59], v[56:57], v[56:57]
  v_pk_add_f32 v[56:57], v[210:211], v[52:53] op_sel_hi:[1,0]
  v_pk_fma_f32 v[58:59], v[56:57], v[56:57], v[58:59]
  v_pk_add_f32 v[56:57], v[212:213], v[52:53] op_sel_hi:[1,0]
  v_pk_fma_f32 v[58:59], v[56:57], v[56:57], v[58:59]
  v_pk_add_f32 v[56:57], v[214:215], v[52:53] op_sel_hi:[1,0]
  v_pk_fma_f32 v[58:59], v[56:57], v[56:57], v[58:59]
  v_pk_add_f32 v[56:57], v[216:217], v[52:53] op_sel_hi:[1,0]
  v_pk_fma_f32 v[58:59], v[56:57], v[56:57], v[58:59]
  v_pk_add_f32 v[56:57], v[218:219], v[52:53] op_sel_hi:[1,0]
  v_pk_fma_f32 v[58:59], v[56:57], v[56:57], v[58:59]
  v_pk_add_f32 v[56:57], v[220:221], v[52:53] op_sel_hi:[1,0]
  v_pk_fma_f32 v[58:59], v[56:57], v[56:57], v[58:59]
  v_pk_add_f32 v[56:57], v[222:223], v[52:53] op_sel_hi:[1,0]
  v_pk_fma_f32 v[58:59], v[56:57], v[56:57], v[58:59]
  v_pk_add_f32 v[56:57], v[224:225], v[52:53] op_sel_hi:[1,0]
  v_pk_fma_f32 v[58:59], v[56:57], v[56:57], v[58:59]
  v_pk_add_f32 v[56:57], v[226:227], v[52:53] op_sel_hi:[1,0]
  v_pk_fma_f32 v[58:59], v[56:57], v[56:57], v[58:59]
  v_add_f32 v58, v58, v59
  v_pk_add_f32 v[208:209], v[208:209], v[54:55] op_sel_hi:[1,0]
  v_cvt_pk_bf16_f32 v6, v208, v209
  v_lshlrev_b32 v208, 16, v6
  v_and_b32 v209, 0xffff0000, v6
  v_add_f32_dpp v58, v58, v58 quad_perm:[1,0,3,2] row_mask:0xf bank_mask:0xf
  v_pk_add_f32 v[210:211], v[210:211], v[54:55] op_sel_hi:[1,0]
  v_cvt_pk_bf16_f32 v6, v210, v211
  v_lshlrev_b32 v210, 16, v6
  v_and_b32 v211, 0xffff0000, v6
  v_add_f32_dpp v58, v58, v58 quad_perm:[2,3,0,1] row_mask:0xf bank_mask:0xf
  v_pk_add_f32 v[212:213], v[212:213], v[54:55] op_sel_hi:[1,0]
  v_cvt_pk_bf16_f32 v6, v212, v213
  v_lshlrev_b32 v212, 16, v6
  v_and_b32 v213, 0xffff0000, v6
  v_add_f32_dpp v58, v58, v58 row_half_mirror row_mask:0xf bank_mask:0xf
  v_pk_add_f32 v[214:215], v[214:215], v[54:55] op_sel_hi:[1,0]
  v_cvt_pk_bf16_f32 v6, v214, v215
  v_lshlrev_b32 v214, 16, v6
  v_and_b32 v215, 0xffff0000, v6
  v_add_f32_dpp v58, v58, v58 row_mirror row_mask:0xf bank_mask:0xf
  v_mov_b32 v59, v58
  s_waitcnt vmcnt(7)
  s_mul_i32 s65, s5, 5120
  buffer_load_dwordx4 v[172:175], v5, s[32:35], s65 offen offset:256
  v_pk_add_f32 v[216:217], v[216:217], v[54:55] op_sel_hi:[1,0]
  v_cvt_pk_bf16_f32 v6, v216, v217
  v_lshlrev_b32 v216, 16, v6
  v_and_b32 v217, 0xffff0000, v6
  v_permlane16_swap_b32 v58, v59
  v_pk_add_f32 v[218:219], v[218:219], v[54:55] op_sel_hi:[1,0]
  v_cvt_pk_bf16_f32 v6, v218, v219
  v_lshlrev_b32 v218, 16, v6
  v_and_b32 v219, 0xffff0000, v6
  v_add_f32 v58, v58, v59
  v_mul_f32 v58, 0x3acccccd, v58
  v_cvt_pk_bf16_f32 v58, 0, v58
  v_add_f32 v58, 0x3727c5ac, v58
  v_cvt_pk_bf16_f32 v58, 0, v58
  v_sqrt_f32 v58, v58
  v_pk_add_f32 v[220:221], v[220:221], v[54:55] op_sel_hi:[1,0]
  v_cvt_pk_bf16_f32 v6, v220, v221
  v_lshlrev_b32 v220, 16, v6
  v_and_b32 v221, 0xffff0000, v6
  v_cvt_pk_bf16_f32 v58, 0, v58
  v_rcp_f32 v58, v58
  v_pk_add_f32 v[222:223], v[222:223], v[54:55] op_sel_hi:[1,0]
  v_cvt_pk_bf16_f32 v6, v222, v223
  v_lshlrev_b32 v222, 16, v6
  v_and_b32 v223, 0xffff0000, v6
  v_pk_add_f32 v[224:225], v[224:225], v[54:55] op_sel_hi:[1,0]
  v_cvt_pk_bf16_f32 v6, v224, v225
  v_lshlrev_b32 v224, 16, v6
  v_and_b32 v225, 0xffff0000, v6
  v_pk_add_f32 v[226:227], v[226:227], v[54:55] op_sel_hi:[1,0]
  v_cvt_pk_bf16_f32 v6, v226, v227
  v_lshlrev_b32 v226, 16, v6
  v_and_b32 v227, 0xffff0000, v6
  v_pk_mul_f32 v[208:209], v[208:209], v[58:59] op_sel_hi:[1,0]
  v_cvt_pk_bf16_f32 v176, v208, v209
  v_pk_mul_f32 v[210:211], v[210:211], v[58:59] op_sel_hi:[1,0]
  v_cvt_pk_bf16_f32 v177, v210, v211
  v_pk_mul_f32 v[212:213], v[212:213], v[58:59] op_sel_hi:[1,0]
  v_cvt_pk_bf16_f32 v178, v212, v213
  v_pk_mul_f32 v[214:215], v[214:215], v[58:59] op_sel_hi:[1,0]
  v_cvt_pk_bf16_f32 v179, v214, v215
  ds_write_b128 v13, v[176:179] offset:27904
  s_waitcnt vmcnt(7)
  s_mul_i32 s65, s5, 5120
  buffer_load_dwordx4 v[172:175], v5, s[32:35], s65 offen offset:512
  v_pk_mul_f32 v[216:217], v[216:217], v[58:59] op_sel_hi:[1,0]
  v_cvt_pk_bf16_f32 v180, v216, v217
  v_pk_mul_f32 v[218:219], v[218:219], v[58:59] op_sel_hi:[1,0]
  v_cvt_pk_bf16_f32 v181, v218, v219
  v_pk_mul_f32 v[220:221], v[220:221], v[58:59] op_sel_hi:[1,0]
  v_cvt_pk_bf16_f32 v182, v220, v221
  v_pk_mul_f32 v[222:223], v[222:223], v[58:59] op_sel_hi:[1,0]
  v_cvt_pk_bf16_f32 v183, v222, v223
  ds_write_b128 v13, v[180:183] offset:28416
  v_pk_mul_f32 v[224:225], v[224:225], v[58:59] op_sel_hi:[1,0]
  v_cvt_pk_bf16_f32 v184, v224, v225
  v_pk_mul_f32 v[226:227], v[226:227], v[58:59] op_sel_hi:[1,0]
  v_cvt_pk_bf16_f32 v185, v226, v227
  ds_write_b64 v94, v[184:185] offset:28928
  s_mul_i32 s65, s5, 5120
  buffer_load_dwordx4 v[172:175], v5, s[32:35], s65 offen offset:768
  s_waitcnt lgkmcnt(0)
  s_barrier
  ds_read_u16 v208, v14 offset:27904
  ds_read_u16 v209, v14 offset:30592
  ds_read_u16 v210, v14 offset:33280
  ds_read_u16 v211, v14 offset:35968
  ds_read_u16 v212, v14 offset:27912
  ds_read_u16 v213, v14 offset:30600
  ds_read_u16 v214, v14 offset:33288
  ds_read_u16 v215, v14 offset:35976
  ds_read_u16 v216, v14 offset:27920
  ds_read_u16 v217, v14 offset:30608
  ds_read_u16 v218, v14 offset:33296
  ds_read_u16 v219, v14 offset:35984
  s_waitcnt lgkmcnt(0)
  ds_read_u16 v220, v14 offset:27928
  ds_read_u16 v221, v14 offset:30616
  ds_read_u16 v222, v14 offset:33304
  ds_read_u16 v223, v14 offset:35992
  ds_read_u16 v224, v14 offset:27936
  ds_read_u16 v225, v14 offset:30624
  ds_read_u16 v226, v14 offset:33312
  ds_read_u16 v227, v14 offset:36000
  s_waitcnt lgkmcnt(0)
  s_waitcnt vmcnt(7)
  s_mul_i32 s65, s5, 5120
  buffer_load_dwordx4 v[172:175], v5, s[32:35], s65 offen offset:1024
  v_lshl_or_b32 v208, v208, 16, v208
  v_and_b32 v16, v208, v8
  v_and_b32 v17, v208, v9
  v_and_b32 v18, v208, v10
  v_and_b32 v19, v208, v11
  s_nop 1
  v_mfma_f32_16x16x32_bf16 v[228:231], v[188:191], v[16:19], 0
  v_lshl_or_b32 v209, v209, 16, v209
  v_and_b32 v20, v209, v8
  v_and_b32 v21, v209, v9
  v_and_b32 v22, v209, v10
  v_and_b32 v23, v209, v11
  s_nop 1
  v_mfma_f32_16x16x32_bf16 v[232:235], v[188:191], v[20:23], 0
  v_lshl_or_b32 v210, v210, 16, v210
  v_and_b32 v16, v210, v8
  v_and_b32 v17, v210, v9
  v_and_b32 v18, v210, v10
  v_and_b32 v19, v210, v11
  s_nop 1
  v_mfma_f32_16x16x32_bf16 v[236:239], v[188:191], v[16:19], 0
  v_lshl_or_b32 v211, v211, 16, v211
  v_and_b32 v20, v211, v8
  v_and_b32 v21, v211, v9
  v_and_b32 v22, v211, v10
  v_and_b32 v23, v211, v11
  s_nop 1
  v_mfma_f32_16x16x32_bf16 v[240:243], v[188:191], v[20:23], 0
  v_lshl_or_b32 v212, v212, 16, v212
  v_and_b32 v16, v212, v8
  v_and_b32 v17, v212, v9
  v_and_b32 v18, v212, v10
  v_and_b32 v19, v212, v11
  s_nop 1
  s_waitcnt vmcnt(7)
  s_mov_b32 s65, 33792
  buffer_load_dwordx4 a[36:39], v2, s[8:11], s65 offen nt
  v_mfma_f32_16x16x32_bf16 v[228:231], v[192:195], v[16:19], v[228:231]
  v_lshl_or_b32 v213, v213, 16, v213
  v_and_b32 v20, v213, v8
  v_and_b32 v21, v213, v9
  v_and_b32 v22, v213, v10
  v_and_b32 v23, v213, v11
  s_nop 1
  v_mfma_f32_16x16x32_bf16 v[232:235], v[192:195], v[20:23], v[232:235]
  v_lshl_or_b32 v214, v214, 16, v214
  v_and_b32 v16, v214, v8
  v_and_b32 v17, v214, v9
  v_and_b32 v18, v214, v10
  v_and_b32 v19, v214, v11
  s_nop 1
  v_mfma_f32_16x16x32_bf16 v[236:239], v[192:195], v[16:19], v[236:239]
  v_lshl_or_b32 v215, v215, 16, v215
  v_and_b32 v20, v215, v8
  v_and_b32 v21, v215, v9
  v_and_b32 v22, v215, v10
  v_and_b32 v23, v215, v11
  s_nop 1
  v_mfma_f32_16x16x32_bf16 v[240:243], v[192:195], v[20:23], v[240:243]
  v_lshl_or_b32 v216, v216, 16, v216
  v_and_b32 v16, v216, v8
  v_and_b32 v17, v216, v9
  v_and_b32 v18, v216, v10
  v_and_b32 v19, v216, v11
  s_nop 1
  v_mfma_f32_16x16x32_bf16 v[228:231], v[196:199], v[16:19], v[228:231]
  v_lshl_or_b32 v217, v217, 16, v217
  v_and_b32 v20, v217, v8
  v_and_b32 v21, v217, v9
  v_and_b32 v22, v217, v10
  s_waitcnt vmcnt(7)
  s_mov_b32 s65, 34816
  buffer_load_dwordx4 a[40:43], v2, s[8:11], s65 offen nt
  v_and_b32 v23, v217, v11
  s_nop 1
  v_mfma_f32_16x16x32_bf16 v[232:235], v[196:199], v[20:23], v[232:235]
  v_lshl_or_b32 v218, v218, 16, v218
  v_and_b32 v16, v218, v8
  v_and_b32 v17, v218, v9
  v_and_b32 v18, v218, v10
  v_and_b32 v19, v218, v11
  s_nop 1
  v_mfma_f32_16x16x32_bf16 v[236:239], v[196:199], v[16:19], v[236:239]
  v_lshl_or_b32 v219, v219, 16, v219
  v_and_b32 v20, v219, v8
  v_and_b32 v21, v219, v9
  v_and_b32 v22, v219, v10
  v_and_b32 v23, v219, v11
  s_nop 1
  v_mfma_f32_16x16x32_bf16 v[240:243], v[196:199], v[20:23], v[240:243]
  v_lshl_or_b32 v220, v220, 16, v220
  v_and_b32 v16, v220, v8
  v_and_b32 v17, v220, v9
  v_and_b32 v18, v220, v10
  v_and_b32 v19, v220, v11
  s_nop 1
  v_mfma_f32_16x16x32_bf16 v[228:231], v[200:203], v[16:19], v[228:231]
  v_lshl_or_b32 v221, v221, 16, v221
  v_and_b32 v20, v221, v8
  v_and_b32 v21, v221, v9
  v_and_b32 v22, v221, v10
  v_and_b32 v23, v221, v11
  s_nop 1
  v_mfma_f32_16x16x32_bf16 v[232:235], v[200:203], v[20:23], v[232:235]
  v_lshl_or_b32 v222, v222, 16, v222
  s_waitcnt vmcnt(7)
  s_mov_b32 s99, 0
  buffer_load_dwordx4 v[96:99], v5, s[20:23], s99 offen offset:0 nt
  v_and_b32 v16, v222, v8
  v_and_b32 v17, v222, v9
  v_and_b32 v18, v222, v10
  v_and_b32 v19, v222, v11
  s_nop 1
  v_mfma_f32_16x16x32_bf16 v[236:239], v[200:203], v[16:19], v[236:239]
  v_lshl_or_b32 v223, v223, 16, v223
  v_and_b32 v20, v223, v8
  v_and_b32 v21, v223, v9
  v_and_b32 v22, v223, v10
  v_and_b32 v23, v223, v11
  s_nop 1
  v_mfma_f32_16x16x32_bf16 v[240:243], v[200:203], v[20:23], v[240:243]
  v_lshl_or_b32 v224, v224, 16, v224
  v_and_b32 v16, v224, v8
  v_and_b32 v17, v224, v9
  v_and_b32 v18, v224, v10
  v_and_b32 v19, v224, v11
  s_nop 1
  v_mfma_f32_16x16x32_bf16 v[228:231], v[204:207], v[16:19], v[228:231]
  v_lshl_or_b32 v225, v225, 16, v225
  v_and_b32 v20, v225, v8
  v_and_b32 v21, v225, v9
  v_and_b32 v22, v225, v10
  v_and_b32 v23, v225, v11
  s_nop 1
  v_mfma_f32_16x16x32_bf16 v[232:235], v[204:207], v[20:23], v[232:235]
  v_lshl_or_b32 v226, v226, 16, v226
  v_and_b32 v16, v226, v8
  v_and_b32 v17, v226, v9
  v_and_b32 v18, v226, v10
  v_and_b32 v19, v226, v11
  s_nop 1
  v_mfma_f32_16x16x32_bf16 v[236:239], v[204:207], v[16:19], v[236:239]
  s_waitcnt vmcnt(7)
  s_mov_b32 s65, 35840
  buffer_load_dwordx4 a[44:47], v2, s[8:11], s65 offen nt
  v_lshl_or_b32 v227, v227, 16, v227
  v_and_b32 v20, v227, v8
  v_and_b32 v21, v227, v9
  v_and_b32 v22, v227, v10
  v_and_b32 v23, v227, v11
  s_nop 1
  v_mfma_f32_16x16x32_bf16 v[240:243], v[204:207], v[20:23], v[240:243]
  s_lshl_b32 s7, s3, 12
  v_add_u32 v52, s7, v90
  v_and_b32 v53, 0x7f0, v3
  v_lshrrev_b32 v54, 7, v0
  v_lshl_add_u32 v53, v54, 3, v53
  s_nop 2
  ds_write_b128 v52, v[228:231] offset:6400
  ds_write_b128 v52, v[232:235] offset:7424
  ds_write_b128 v52, v[236:239] offset:8448
  ds_write_b128 v52, v[240:243] offset:9472
  s_mov_b32 s65, 36864
  buffer_load_dwordx4 a[48:51], v2, s[8:11], s65 offen nt
  s_waitcnt lgkmcnt(0)
  s_barrier
  ds_read_b128 v[208:211], v3 offset:6400
  ds_read_b128 v[212:215], v3 offset:10496
  ds_read_b128 v[216:219], v3 offset:14592
  ds_read_b128 v[220:223], v3 offset:18688
  s_getreg_b32 s77, hwreg(HW_REG_XCC_ID, 0, 4)
  s_add_u32 s77, s77, 1
  s_and_b32 s78, s2, 7
  s_lshl_b32 s78, s78, 2
  s_waitcnt lgkmcnt(0)
  s_waitcnt vmcnt(7)
  s_mov_b32 s65, 37888
  buffer_load_dwordx4 a[52:55], v2, s[8:11], s65 offen nt
  v_pk_add_f32 v[208:209], v[208:209], v[212:213]
  v_pk_add_f32 v[216:217], v[216:217], v[220:221]
  v_pk_add_f32 v[208:209], v[208:209], v[216:217]
  v_pk_add_f32 v[210:211], v[210:211], v[214:215]
  v_pk_add_f32 v[218:219], v[218:219], v[222:223]
  v_pk_add_f32 v[210:211], v[210:211], v[218:219]
  buffer_store_dwordx4 v[208:211], v74, s[28:31], s67 offen
  s_waitcnt vmcnt(8)
  s_mov_b32 s99, 0
  buffer_load_dwordx4 v[104:107], v5, s[20:23], s99 offen offset:256 nt
  s_waitcnt vmcnt(8)
  s_mov_b32 s65, 38912
  buffer_load_dwordx4 a[56:59], v2, s[8:11], s65 offen nt
  s_waitcnt vmcnt(8)
  s_mov_b32 s65, 39936
  buffer_load_dwordx4 a[60:63], v2, s[8:11], s65 offen nt
  s_waitcnt vmcnt(8)
  s_mov_b32 s65, 65536
  buffer_load_dwordx4 a[64:67], v2, s[8:11], s65 offen nt
  s_waitcnt vmcnt(8)
  s_mov_b32 s99, 0
  buffer_load_dwordx4 v[112:115], v5, s[20:23], s99 offen offset:512 nt
  s_waitcnt vmcnt(8)
  s_mov_b32 s65, 66560
  buffer_load_dwordx4 a[68:71], v2, s[8:11], s65 offen nt
  s_waitcnt vmcnt(8)
  s_mov_b32 s65, 67584
  buffer_load_dwordx4 a[72:75], v2, s[8:11], s65 offen nt
  s_waitcnt vmcnt(8)
  s_mov_b32 s65, 68608
  buffer_load_dwordx4 a[76:79], v2, s[8:11], s65 offen nt
  s_waitcnt vmcnt(8)
  s_mov_b32 s99, 0
  buffer_load_dwordx4 v[120:123], v5, s[20:23], s99 offen offset:768 nt
  s_waitcnt vmcnt(8)
  s_mov_b32 s65, 69632
  buffer_load_dwordx4 a[80:83], v2, s[8:11], s65 offen nt
  s_waitcnt vmcnt(8)
  s_mov_b32 s65, 70656
  buffer_load_dwordx4 a[84:87], v2, s[8:11], s65 offen nt
  s_waitcnt vmcnt(8)
  s_mov_b32 s65, 71680
  buffer_load_dwordx4 a[88:91], v2, s[8:11], s65 offen nt
  s_waitcnt vmcnt(8)
  s_mov_b32 s99, 0
  buffer_load_dwordx4 v[128:131], v5, s[20:23], s99 offen offset:1024 nt
  s_waitcnt vmcnt(8)
  s_mov_b32 s65, 72704
  buffer_load_dwordx4 a[92:95], v2, s[8:11], s65 offen nt
  s_waitcnt vmcnt(8)
  s_mov_b32 s65, 98304
  buffer_load_dwordx4 a[96:99], v2, s[8:11], s65 offen nt
  s_waitcnt vmcnt(8)
  s_mov_b32 s65, 99328
  buffer_load_dwordx4 a[100:103], v2, s[8:11], s65 offen nt
  s_waitcnt vmcnt(8)
  s_mov_b32 s99, 5120
  buffer_load_dwordx4 v[100:103], v5, s[20:23], s99 offen offset:0 nt
  s_waitcnt vmcnt(8)
  s_mov_b32 s65, 100352
  buffer_load_dwordx4 a[104:107], v2, s[8:11], s65 offen nt
  s_load_dword s79, s[60:61], s78
  s_waitcnt vmcnt(8)
  s_mov_b32 s65, 101376
  buffer_load_dwordx4 a[108:111], v2, s[8:11], s65 offen nt
  s_waitcnt vmcnt(8)
  s_mov_b32 s65, 102400
  buffer_load_dwordx4 a[112:115], v2, s[8:11], s65 offen nt
  s_waitcnt vmcnt(8)
  s_mov_b32 s99, 5120
  buffer_load_dwordx4 v[108:111], v5, s[20:23], s99 offen offset:256 nt
  s_lshl_b32 s75, s78, 10
  s_add_u32 s75, s75, 163840
  s_lshr_b32 s7, s2, 3
  s_lshl_b32 s74, s7, 7
  s_add_u32 s74, s74, s75
  s_and_b32 s7, s7, 3
  s_lshl_b32 s7, s7, 7
  s_add_u32 s75, s75, s7
  v_mov_b32 v53, 1
  s_and_b32 s7, s5, 4
  s_add_u32 s7, s7, s3
  v_lshrrev_b32 v52, 5, v0
  v_lshlrev_b32 v52, 9, v52
  s_mov_b32 s64, 0
  s_waitcnt lgkmcnt(0)
  s_cmp_eq_u32 s79, s77
  s_cbranch_scc0 L_lslow
L_lok:
  s_barrier
  s_cmp_eq_u32 s3, 0
  s_cbranch_scc0 L_noqf
  s_mov_b64 exec, 1
  buffer_store_dword v53, off, s[28:31], s74
  s_mov_b64 exec, -1
L_noqf:
  s_waitcnt vmcnt(7)
  s_mov_b32 s65, 103424
  buffer_load_dwordx4 a[116:119], v2, s[8:11], s65 offen nt
  v_and_b32 v57, 3, v0
  v_bfe_u32 v56, v0, 5, 1
  v_lshl_add_u32 v56, v57, 1, v56
  v_add_u32 v56, 0, v56
  v_and_b32 v56, 7, v56
  v_bfe_u32 v58, v0, 4, 1
  v_lshl_add_u32 v56, v56, 1, v58
  v_bfe_u32 v58, v0, 2, 1
  v_lshl_add_u32 v56, v56, 1, v58
  s_lshl_b32 s7, s3, 5
  v_add_lshl_u32 v4, v56, s7, 2
  v_and_b32 v58, 7, v56
  s_lshl_b32 s7, s3, 4
  v_add_lshl_u32 v58, v58, s7, 4
  v_lshrrev_b32 v56, 3, v56
  v_lshl_add_u32 v84, v56, 2, v58
  v_lshrrev_b32 v56, 2, v0
  v_lshl_add_u32 v58, v56, 3, v57
  v_add_u32 v58, 0, v58
  v_lshrrev_b32 v59, 7, v58
  v_bfe_u32 v60, v58, 2, 1
  v_lshl_add_u32 v59, v59, 2, v60
  v_bfe_u32 v60, v58, 3, 4
  v_lshl_add_u32 v59, v59, 4, v60
  v_and_b32 v60, 3, v58
  v_lshl_add_u32 v59, v59, 2, v60
  v_lshlrev_b32 v85, 2, v59
  v_lshl_add_u32 v58, v56, 3, v57
  v_add_u32 v58, 3, v58
  v_lshrrev_b32 v59, 7, v58
  v_bfe_u32 v60, v58, 2, 1
  v_lshl_add_u32 v59, v59, 2, v60
  v_bfe_u32 v60, v58, 3, 4
  v_lshl_add_u32 v59, v59, 4, v60
  v_and_b32 v60, 3, v58
  v_lshl_add_u32 v59, v59, 2, v60
  v_lshlrev_b32 v86, 2, v59
  v_lshl_add_u32 v58, v56, 3, v57
  v_add_u32 v58, 6, v58
  v_lshrrev_b32 v59, 7, v58
  v_bfe_u32 v60, v58, 2, 1
  v_lshl_add_u32 v59, v59, 2, v60
  v_bfe_u32 v60, v58, 3, 4
  v_lshl_add_u32 v59, v59, 4, v60
  v_and_b32 v60, 3, v58
  v_lshl_add_u32 v59, v59, 2, v60
  v_lshlrev_b32 v87, 2, v59
  s_waitcnt vmcnt(7)
  s_mov_b32 s65, 104448
  buffer_load_dwordx4 a[120:123], v2, s[8:11], s65 offen nt
  v_lshl_add_u32 v58, v56, 1, v57
  v_add_u32 v58, 512, v58
  v_lshrrev_b32 v59, 7, v58
  v_bfe_u32 v60, v58, 2, 1
  v_lshl_add_u32 v59, v59, 2, v60
  v_bfe_u32 v60, v58, 3, 4
  v_lshl_add_u32 v59, v59, 4, v60
  v_and_b32 v60, 3, v58
  v_lshl_add_u32 v59, v59, 2, v60
  v_lshlrev_b32 v88, 2, v59
  s_waitcnt vmcnt(7)
  s_mov_b32 s65, 105472
  buffer_load_dwordx4 a[124:127], v2, s[8:11], s65 offen nt
  s_waitcnt vmcnt(7)
  s_mov_b32 s99, 5120
  buffer_load_dwordx4 v[116:119], v5, s[20:23], s99 offen offset:512 nt
  s_waitcnt vmcnt(7)
  s_mov_b32 s65, 131072
  buffer_load_dwordx4 a[128:131], v2, s[8:11], s65 offen nt
  s_waitcnt vmcnt(7)
  s_mov_b32 s65, 132096
  buffer_load_dwordx4 a[132:135], v2, s[8:11], s65 offen nt
  s_waitcnt vmcnt(7)
  s_mov_b32 s65, 133120
  buffer_load_dwordx4 a[136:139], v2, s[8:11], s65 offen nt
  s_waitcnt vmcnt(7)
  s_mov_b32 s99, 5120
  buffer_load_dwordx4 v[124:127], v5, s[20:23], s99 offen offset:768 nt
  s_waitcnt vmcnt(7)
  s_mov_b32 s65, 134144
  buffer_load_dwordx4 a[140:143], v2, s[8:11], s65 offen nt
  s_waitcnt vmcnt(7)
  s_mov_b32 s65, 135168
  buffer_load_dwordx4 a[144:147], v2, s[8:11], s65 offen nt
  s_waitcnt vmcnt(7)
  s_mov_b32 s65, 136192
  buffer_load_dwordx4 a[148:151], v2, s[8:11], s65 offen nt
  s_waitcnt vmcnt(7)
  s_mov_b32 s65, 137216
  buffer_load_dwordx4 a[152:155], v2, s[8:11], s65 offen nt
  s_waitcnt vmcnt(7)
  s_mov_b32 s99, 5120
  buffer_load_dwordx4 v[132:135], v5, s[20:23], s99 offen offset:1024 nt
  s_waitcnt vmcnt(7)
  s_mov_b32 s65, 138240
  buffer_load_dwordx4 a[156:159], v2, s[8:11], s65 offen nt
  s_waitcnt vmcnt(7)
  s_mov_b32 s65, 163840
  buffer_load_dwordx4 a[160:163], v2, s[8:11], s65 offen nt
  s_waitcnt vmcnt(7)
  s_mov_b32 s65, 164864
  buffer_load_dwordx4 a[164:167], v2, s[8:11], s65 offen nt
  s_waitcnt vmcnt(7)
  s_mov_b32 s99, 10240
  buffer_load_dwordx4 v[136:139], v5, s[20:23], s99 offen offset:0 nt
  s_waitcnt vmcnt(7)
  s_mov_b32 s65, 165888
  buffer_load_dwordx4 a[168:171], v2, s[8:11], s65 offen nt
  s_waitcnt vmcnt(7)
  s_mov_b32 s65, 166912
  buffer_load_dwordx4 a[172:175], v2, s[8:11], s65 offen nt
  s_waitcnt vmcnt(7)
  s_mov_b32 s65, 167936
  buffer_load_dwordx4 a[176:179], v2, s[8:11], s65 offen nt
  s_waitcnt vmcnt(7)
  s_mov_b32 s99, 10240
  buffer_load_dwordx4 v[144:147], v5, s[20:23], s99 offen offset:256 nt
  s_waitcnt vmcnt(7)
  s_mov_b32 s65, 168960
  buffer_load_dwordx4 a[180:183], v2, s[8:11], s65 offen nt
  s_waitcnt vmcnt(7)
  s_mov_b32 s65, 169984
  buffer_load_dwordx4 a[184:187], v2, s[8:11], s65 offen nt
  s_waitcnt vmcnt(7)
  s_mov_b32 s65, 171008
  buffer_load_dwordx4 a[188:191], v2, s[8:11], s65 offen nt
  s_waitcnt vmcnt(7)
  s_mov_b32 s99, 10240
  buffer_load_dwordx4 v[152:155], v5, s[20:23], s99 offen offset:512 nt
  s_waitcnt vmcnt(7)
  s_mov_b32 s65, 196608
  buffer_load_dwordx4 a[192:195], v2, s[8:11], s65 offen nt
  s_waitcnt vmcnt(7)
  s_mov_b32 s65, 197632
  buffer_load_dwordx4 a[196:199], v2, s[8:11], s65 offen nt
  s_waitcnt vmcnt(7)
  s_mov_b32 s65, 198656
  buffer_load_dwordx4 a[200:203], v2, s[8:11], s65 offen nt
  s_waitcnt vmcnt(7)
  s_mov_b32 s99, 10240
  buffer_load_dwordx4 v[160:163], v5, s[20:23], s99 offen offset:768 nt
  s_waitcnt vmcnt(7)
  s_mov_b32 s65, 199680
  buffer_load_dwordx4 a[204:207], v2, s[8:11], s65 offen nt
  s_waitcnt vmcnt(7)
  s_mov_b32 s65, 200704
  buffer_load_dwordx4 a[208:211], v2, s[8:11], s65 offen nt
  buffer_load_dword v54, v52, s[28:31], s75 offen sc1
  s_waitcnt vmcnt(8)
  s_mov_b32 s65, 201728
  buffer_load_dwordx4 a[212:215], v2, s[8:11], s65 offen nt
  s_waitcnt vmcnt(8)
  s_mov_b32 s99, 10240
  buffer_load_dwordx4 v[168:171], v5, s[20:23], s99 offen offset:1024 nt
  s_waitcnt vmcnt(8)
  s_mov_b32 s65, 202752
  buffer_load_dwordx4 a[216:219], v2, s[8:11], s65 offen nt
  s_waitcnt vmcnt(8)
  s_mov_b32 s65, 203776
  buffer_load_dwordx4 a[220:223], v2, s[8:11], s65 offen nt
  s_waitcnt vmcnt(8)
  s_mov_b32 s65, 229376
  buffer_load_dwordx4 a[224:227], v2, s[8:11], s65 offen nt
  s_waitcnt vmcnt(8)
  s_mov_b32 s99, 15360
  buffer_load_dwordx4 v[140:143], v5, s[20:23], s99 offen offset:0 nt
  s_waitcnt vmcnt(8)
  s_mov_b32 s65, 230400
  buffer_load_dwordx4 a[228:231], v2, s[8:11], s65 offen nt
  s_waitcnt vmcnt(8)
  s_mov_b32 s65, 231424
  buffer_load_dwordx4 a[232:235], v2, s[8:11], s65 offen nt
  s_waitcnt vmcnt(8)
  s_add_u32 s66, s66, 229376
  v_cmp_eq_u32 vcc, 0, v54
  s_cbranch_vccnz L_qslow
L_qok:
  buffer_load_dwordx4 v[64:67], v3, s[28:31], s66 offen sc1
  v_bfe_u32 v54, v0, 3, 2
  v_and_b32 v55, 7, v0
  v_lshl_add_u32 v54, v54, 5, v55
  v_bfe_u32 v55, v0, 5, 0
  v_lshl_add_u32 v54, v55, 4, v54
  s_lshl_b32 s7, s3, 9
  v_lshl_add_u32 v54, v54, 2, s7
  v_and_b32 v55, 3, v0
  v_lshl_add_u32 v55, v7, 2, v55
  v_lshlrev_b32 v55, 5, v55
  s_waitcnt vmcnt(8)
  s_mov_b32 s65, 232448
  buffer_load_dwordx4 a[236:239], v2, s[8:11], s65 offen nt
  s_waitcnt vmcnt(8)
  s_mov_b32 s99, 15360
  buffer_load_dwordx4 v[148:151], v5, s[20:23], s99 offen offset:256 nt
  s_waitcnt vmcnt(8)
  s_mov_b32 s65, 233472
  buffer_load_dwordx4 a[240:243], v2, s[8:11], s65 offen nt
  s_waitcnt vmcnt(8)
  s_mov_b32 s65, 234496
  buffer_load_dwordx4 a[244:247], v2, s[8:11], s65 offen nt
  s_waitcnt vmcnt(8)
  s_mov_b32 s65, 235520
  buffer_load_dwordx4 a[248:251], v2, s[8:11], s65 offen nt
  s_waitcnt vmcnt(8)
  s_mov_b32 s99, 15360
  buffer_load_dwordx4 v[156:159], v5, s[20:23], s99 offen offset:512 nt
  s_waitcnt vmcnt(8)
  s_mov_b32 s65, 236544
  buffer_load_dwordx4 a[252:255], v2, s[8:11], s65 offen nt
  s_waitcnt vmcnt(8)
  s_mov_b32 s65, 0
  buffer_load_dwordx4 v[208:211], v63, s[12:15], s65 offen nt
  s_waitcnt vmcnt(8)
  v_mov_b32 v68, v64
  v_mov_b32 v69, v65
  v_mov_b32 v70, v66
  v_mov_b32 v71, v67
  v_permlane32_swap_b32 v64, v68
  v_permlane32_swap_b32 v65, v69
  v_permlane32_swap_b32 v66, v70
  v_permlane32_swap_b32 v67, v71
  v_add_f32 v64, v64, v68
  v_add_f32 v65, v65, v69
  v_add_f32 v66, v66, v70
  v_add_f32 v67, v67, v71
  s_cmp_lg_u32 s64, 0
  s_cbranch_scc1 L_qlocal
L_qjoin:
  ds_write_b32 v54, v64 offset:0
  ds_write_b32 v54, v65 offset:32
  ds_write_b32 v54, v66 offset:64
  ds_write_b32 v54, v67 offset:96
  s_mov_b32 s65, 1024
  buffer_load_dwordx4 v[212:215], v63, s[12:15], s65 offen nt
  s_waitcnt lgkmcnt(0)
  s_barrier
  ds_read_b128 v[176:179], v55 offset:0
  ds_read_b128 v[180:183], v55 offset:16
  ds_read_b128 v[184:187], v55 offset:512
  ds_read_b128 v[188:191], v55 offset:528
  ds_read_b128 v[192:195], v55 offset:1024
  ds_read_b128 v[196:199], v55 offset:1040
  ds_read_b128 v[200:203], v55 offset:1536
  ds_read_b128 v[204:207], v55 offset:1552
  s_waitcnt lgkmcnt(0)
  s_waitcnt vmcnt(7)
  s_mov_b32 s99, 15360
  buffer_load_dwordx4 v[164:167], v5, s[20:23], s99 offen offset:768 nt
  v_pk_add_f32 v[176:177], v[176:177], v[184:185]
  v_pk_add_f32 v[192:193], v[192:193], v[200:201]
  v_pk_add_f32 v[176:177], v[176:177], v[192:193]
  v_pk_add_f32 v[178:179], v[178:179], v[186:187]
  v_pk_add_f32 v[194:195], v[194:195], v[202:203]
  v_pk_add_f32 v[178:179], v[178:179], v[194:195]
  v_pk_add_f32 v[180:181], v[180:181], v[188:189]
  v_pk_add_f32 v[196:197], v[196:197], v[204:205]
  v_pk_add_f32 v[180:181], v[180:181], v[196:197]
  v_pk_add_f32 v[182:183], v[182:183], v[190:191]
  v_pk_add_f32 v[198:199], v[198:199], v[206:207]
  v_pk_add_f32 v[182:183], v[182:183], v[198:199]
  v_cvt_pk_bf16_f32 v176, v176, v177
  v_cvt_pk_bf16_f32 v177, v178, v179
  v_cvt_pk_bf16_f32 v178, v180, v181
  v_cvt_pk_bf16_f32 v179, v182, v183
  s_mov_b32 s68, 0xf000f
  s_mov_b32 s69, 0xf000f
  v_cndmask_b32 v32, 0, v176, s[68:69]
  v_cndmask_b32 v33, 0, v177, s[68:69]
  v_cndmask_b32 v34, 0, v178, s[68:69]
  v_cndmask_b32 v35, 0, v179, s[68:69]
  s_mov_b32 s68, 0xf000f0
  s_mov_b32 s69, 0xf000f0
  v_cndmask_b32 v36, 0, v176, s[68:69]
  v_cndmask_b32 v37, 0, v177, s[68:69]
  v_cndmask_b32 v38, 0, v178, s[68:69]
  v_cndmask_b32 v39, 0, v179, s[68:69]
  s_mov_b32 s68, 0xf000f00
  s_mov_b32 s69, 0xf000f00
  v_cndmask_b32 v40, 0, v176, s[68:69]
  v_cndmask_b32 v41, 0, v177, s[68:69]
  v_cndmask_b32 v42, 0, v178, s[68:69]
  v_cndmask_b32 v43, 0, v179, s[68:69]
  s_mov_b32 s68, 0xf000f000
  s_mov_b32 s69, 0xf000f000
  v_cndmask_b32 v44, 0, v176, s[68:69]
  v_cndmask_b32 v45, 0, v177, s[68:69]
  v_cndmask_b32 v46, 0, v178, s[68:69]
  v_cndmask_b32 v47, 0, v179, s[68:69]
  s_mov_b32 s70, 0x22222222
  s_mov_b32 s71, 0x22222222
  s_mov_b32 s72, 0x44444444
  s_mov_b32 s73, 0x44444444
  s_mov_b32 s74, 0x88888888
  s_mov_b32 s75, 0x88888888
  v_mfma_f32_16x16x32_bf16 v[24:27], a[0:3], v[32:35], 0
  s_waitcnt vmcnt(7)
  s_mov_b32 s65, 2048
  buffer_load_dwordx4 v[216:219], v63, s[12:15], s65 offen nt
  v_mfma_f32_16x16x32_bf16 v[24:27], a[4:7], v[36:39], v[24:27]
  v_mfma_f32_16x16x32_bf16 v[24:27], a[8:11], v[40:43], v[24:27]
  v_mfma_f32_16x16x32_bf16 v[24:27], a[12:15], v[44:47], v[24:27]
  s_nop 4
  v_mfma_f32_16x16x32_bf16 v[28:31], a[16:19], v[32:35], 0
  v_mfma_f32_16x16x32_bf16 v[28:31], a[20:23], v[36:39], v[28:31]
  v_mfma_f32_16x16x32_bf16 v[28:31], a[24:27], v[40:43], v[28:31]
  v_mfma_f32_16x16x32_bf16 v[28:31], a[28:31], v[44:47], v[28:31]
  v_mov_b32_dpp v52, v24 quad_perm:[0,0,0,0] row_mask:0xf bank_mask:0xf
  v_add_f32_dpp v52, v25, v52 quad_perm:[1,1,1,1] row_mask:0xf bank_mask:0xf
  v_add_f32_dpp v52, v26, v52 quad_perm:[2,2,2,2] row_mask:0xf bank_mask:0xf
  v_add_f32_dpp v48, v27, v52 quad_perm:[3,3,3,3] row_mask:0xf bank_mask:0xf
  s_nop 0
  v_mfma_f32_16x16x32_bf16 v[24:27], a[32:35], v[32:35], 0
  v_mfma_f32_16x16x32_bf16 v[24:27], a[36:39], v[36:39], v[24:27]
  v_mfma_f32_16x16x32_bf16 v[24:27], a[40:43], v[40:43], v[24:27]
  v_mfma_f32_16x16x32_bf16 v[24:27], a[44:47], v[44:47], v[24:27]
  v_mov_b32_dpp v52, v28 quad_perm:[0,0,0,0] row_mask:0xf bank_mask:0xf
  v_add_f32_dpp v52, v29, v52 quad_perm:[1,1,1,1] row_mask:0xf bank_mask:0xf
  v_add_f32_dpp v52, v30, v52 quad_perm:[2,2,2,2] row_mask:0xf bank_mask:0xf
  v_add_f32_dpp v52, v31, v52 quad_perm:[3,3,3,3] row_mask:0xf bank_mask:0xf
  v_cndmask_b32 v48, v48, v52, s[70:71]
  s_waitcnt vmcnt(7)
  s_mov_b32 s65, 3072
  buffer_load_dwordx4 v[220:223], v63, s[12:15], s65 offen nt
  v_mfma_f32_16x16x32_bf16 v[28:31], a[48:51], v[32:35], 0
  v_mfma_f32_16x16x32_bf16 v[28:31], a[52:55], v[36:39], v[28:31]
  v_mfma_f32_16x16x32_bf16 v[28:31], a[56:59], v[40:43], v[28:31]
  v_mfma_f32_16x16x32_bf16 v[28:31], a[60:63], v[44:47], v[28:31]
  v_mov_b32_dpp v52, v24 quad_perm:[0,0,0,0] row_mask:0xf bank_mask:0xf
  v_add_f32_dpp v52, v25, v52 quad_perm:[1,1,1,1] row_mask:0xf bank_mask:0xf
  v_add_f32_dpp v52, v26, v52 quad_perm:[2,2,2,2] row_mask:0xf bank_mask:0xf
  v_add_f32_dpp v52, v27, v52 quad_perm:[3,3,3,3] row_mask:0xf bank_mask:0xf
  v_cndmask_b32 v48, v48, v52, s[72:73]
  v_mfma_f32_16x16x32_bf16 v[24:27], a[64:67], v[32:35], 0
  v_mfma_f32_16x16x32_bf16 v[24:27], a[68:71], v[36:39], v[24:27]
  v_mfma_f32_16x16x32_bf16 v[24:27], a[72:75], v[40:43], v[24:27]
  v_mfma_f32_16x16x32_bf16 v[24:27], a[76:79], v[44:47], v[24:27]
  v_mov_b32_dpp v52, v28 quad_perm:[0,0,0,0] row_mask:0xf bank_mask:0xf
  v_add_f32_dpp v52, v29, v52 quad_perm:[1,1,1,1] row_mask:0xf bank_mask:0xf
  v_add_f32_dpp v52, v30, v52 quad_perm:[2,2,2,2] row_mask:0xf bank_mask:0xf
  v_add_f32_dpp v52, v31, v52 quad_perm:[3,3,3,3] row_mask:0xf bank_mask:0xf
  v_cndmask_b32 v48, v48, v52, s[74:75]
  v_mfma_f32_16x16x32_bf16 v[28:31], a[80:83], v[32:35], 0
  v_mfma_f32_16x16x32_bf16 v[28:31], a[84:87], v[36:39], v[28:31]
  v_mfma_f32_16x16x32_bf16 v[28:31], a[88:91], v[40:43], v[28:31]
  v_mfma_f32_16x16x32_bf16 v[28:31], a[92:95], v[44:47], v[28:31]
  v_mov_b32_dpp v52, v24 quad_perm:[0,0,0,0] row_mask:0xf bank_mask:0xf
  s_waitcnt vmcnt(7)
  s_mov_b32 s99, 15360
  buffer_load_dwordx4 v[172:175], v5, s[20:23], s99 offen offset:1024 nt
  v_add_f32_dpp v52, v25, v52 quad_perm:[1,1,1,1] row_mask:0xf bank_mask:0xf
  v_add_f32_dpp v52, v26, v52 quad_perm:[2,2,2,2] row_mask:0xf bank_mask:0xf
  v_add_f32_dpp v49, v27, v52 quad_perm:[3,3,3,3] row_mask:0xf bank_mask:0xf
  s_nop 0
  v_mfma_f32_16x16x32_bf16 v[24:27], a[96:99], v[32:35], 0
  v_mfma_f32_16x16x32_bf16 v[24:27], a[100:103], v[36:39], v[24:27]
  v_mfma_f32_16x16x32_bf16 v[24:27], a[104:107], v[40:43], v[24:27]
  v_mfma_f32_16x16x32_bf16 v[24:27], a[108:111], v[44:47], v[24:27]
  v_mov_b32_dpp v52, v28 quad_perm:[0,0,0,0] row_mask:0xf bank_mask:0xf
  v_add_f32_dpp v52, v29, v52 quad_perm:[1,1,1,1] row_mask:0xf bank_mask:0xf
  v_add_f32_dpp v52, v30, v52 quad_perm:[2,2,2,2] row_mask:0xf bank_mask:0xf
  v_add_f32_dpp v52, v31, v52 quad_perm:[3,3,3,3] row_mask:0xf bank_mask:0xf
  v_cndmask_b32 v49, v49, v52, s[70:71]
  v_mfma_f32_16x16x32_bf16 v[28:31], a[112:115], v[32:35], 0
  v_mfma_f32_16x16x32_bf16 v[28:31], a[116:119], v[36:39], v[28:31]
  v_mfma_f32_16x16x32_bf16 v[28:31], a[120:123], v[40:43], v[28:31]
  v_mfma_f32_16x16x32_bf16 v[28:31], a[124:127], v[44:47], v[28:31]
  v_mov_b32_dpp v52, v24 quad_perm:[0,0,0,0] row_mask:0xf bank_mask:0xf
  v_add_f32_dpp v52, v25, v52 quad_perm:[1,1,1,1] row_mask:0xf bank_mask:0xf
  v_add_f32_dpp v52, v26, v52 quad_perm:[2,2,2,2] row_mask:0xf bank_mask:0xf
  v_add_f32_dpp v52, v27, v52 quad_perm:[3,3,3,3] row_mask:0xf bank_mask:0xf
  v_cndmask_b32 v49, v49, v52, s[72:73]
  v_mfma_f32_16x16x32_bf16 v[24:27], a[128:131], v[32:35], 0
  v_mfma_f32_16x16x32_bf16 v[24:27], a[132:135], v[36:39], v[24:27]
  v_mfma_f32_16x16x32_bf16 v[24:27], a[136:139], v[40:43], v[24:27]
  s_waitcnt vmcnt(7)
  s_mov_b32 s65, 4096
  buffer_load_dwordx4 v[224:227], v63, s[12:15], s65 offen nt
  v_mfma_f32_16x16x32_bf16 v[24:27], a[140:143], v[44:47], v[24:27]
  v_mov_b32_dpp v52, v28 quad_perm:[0,0,0,0] row_mask:0xf bank_mask:0xf
  v_add_f32_dpp v52, v29, v52 quad_perm:[1,1,1,1] row_mask:0xf bank_mask:0xf
  v_add_f32_dpp v52, v30, v52 quad_perm:[2,2,2,2] row_mask:0xf bank_mask:0xf
  v_add_f32_dpp v52, v31, v52 quad_perm:[3,3,3,3] row_mask:0xf bank_mask:0xf
  v_cndmask_b32 v49, v49, v52, s[74:75]
  v_mfma_f32_16x16x32_bf16 v[28:31], a[144:147], v[32:35], 0
  v_mfma_f32_16x16x32_bf16 v[28:31], a[148:151], v[36:39], v[28:31]
  v_mfma_f32_16x16x32_bf16 v[28:31], a[152:155], v[40:43], v[28:31]
  v_mfma_f32_16x16x32_bf16 v[28:31], a[156:159], v[44:47], v[28:31]
  v_mov_b32_dpp v52, v24 quad_perm:[0,0,0,0] row_mask:0xf bank_mask:0xf
  v_add_f32_dpp v52, v25, v52 quad_perm:[1,1,1,1] row_mask:0xf bank_mask:0xf
  v_add_f32_dpp v52, v26, v52 quad_perm:[2,2,2,2] row_mask:0xf bank_mask:0xf
  v_add_f32_dpp v50, v27, v52 quad_perm:[3,3,3,3] row_mask:0xf bank_mask:0xf
  s_nop 0
  v_mfma_f32_16x16x32_bf16 v[24:27], a[160:163], v[32:35], 0
  v_mfma_f32_16x16x32_bf16 v[24:27], a[164:167], v[36:39], v[24:27]
  v_mfma_f32_16x16x32_bf16 v[24:27], a[168:171], v[40:43], v[24:27]
  v_mfma_f32_16x16x32_bf16 v[24:27], a[172:175], v[44:47], v[24:27]
  v_mov_b32_dpp v52, v28 quad_perm:[0,0,0,0] row_mask:0xf bank_mask:0xf
  v_add_f32_dpp v52, v29, v52 quad_perm:[1,1,1,1] row_mask:0xf bank_mask:0xf
  v_add_f32_dpp v52, v30, v52 quad_perm:[2,2,2,2] row_mask:0xf bank_mask:0xf
  v_add_f32_dpp v52, v31, v52 quad_perm:[3,3,3,3] row_mask:0xf bank_mask:0xf
  v_cndmask_b32 v50, v50, v52, s[70:71]
  v_mfma_f32_16x16x32_bf16 v[28:31], a[176:179], v[32:35], 0
  v_mfma_f32_16x16x32_bf16 v[28:31], a[180:183], v[36:39], v[28:31]
  s_waitcnt vmcnt(7)
  s_mov_b32 s65, 5120
  buffer_load_dwordx4 v[228:231], v63, s[12:15], s65 offen nt
  v_mfma_f32_16x16x32_bf16 v[28:31], a[184:187], v[40:43], v[28:31]
  v_mfma_f32_16x16x32_bf16 v[28:31], a[188:191], v[44:47], v[28:31]
  v_mov_b32_dpp v52, v24 quad_perm:[0,0,0,0] row_mask:0xf bank_mask:0xf
  v_add_f32_dpp v52, v25, v52 quad_perm:[1,1,1,1] row_mask:0xf bank_mask:0xf
  v_add_f32_dpp v52, v26, v52 quad_perm:[2,2,2,2] row_mask:0xf bank_mask:0xf
  v_add_f32_dpp v52, v27, v52 quad_perm:[3,3,3,3] row_mask:0xf bank_mask:0xf
  v_cndmask_b32 v50, v50, v52, s[72:73]
  v_mfma_f32_16x16x32_bf16 v[24:27], a[192:195], v[32:35], 0
  v_mfma_f32_16x16x32_bf16 v[24:27], a[196:199], v[36:39], v[24:27]
  v_mfma_f32_16x16x32_bf16 v[24:27], a[200:203], v[40:43], v[24:27]
  v_mfma_f32_16x16x32_bf16 v[24:27], a[204:207], v[44:47], v[24:27]
  v_mov_b32_dpp v52, v28 quad_perm:[0,0,0,0] row_mask:0xf bank_mask:0xf
  v_add_f32_dpp v52, v29, v52 quad_perm:[1,1,1,1] row_mask:0xf bank_mask:0xf
  v_add_f32_dpp v52, v30, v52 quad_perm:[2,2,2,2] row_mask:0xf bank_mask:0xf
  v_add_f32_dpp v52, v31, v52 quad_perm:[3,3,3,3] row_mask:0xf bank_mask:0xf
  v_cndmask_b32 v50, v50, v52, s[74:75]
  v_mfma_f32_16x16x32_bf16 v[28:31], a[208:211], v[32:35], 0
  v_mfma_f32_16x16x32_bf16 v[28:31], a[212:215], v[36:39], v[28:31]
  v_mfma_f32_16x16x32_bf16 v[28:31], a[216:219], v[40:43], v[28:31]
  v_mfma_f32_16x16x32_bf16 v[28:31], a[220:223], v[44:47], v[28:31]
  v_mov_b32_dpp v52, v24 quad_perm:[0,0,0,0] row_mask:0xf bank_mask:0xf
  v_add_f32_dpp v52, v25, v52 quad_perm:[1,1,1,1] row_mask:0xf bank_mask:0xf
  v_add_f32_dpp v52, v26, v52 quad_perm:[2,2,2,2] row_mask:0xf bank_mask:0xf
  v_add_f32_dpp v51, v27, v52 quad_perm:[3,3,3,3] row_mask:0xf bank_mask:0xf
  s_nop 0
  v_mfma_f32_16x16x32_bf16 v[24:27], a[224:227], v[32:35], 0
  s_waitcnt vmcnt(7)
  s_mov_b32 s99, 20480
  buffer_load_dwordx4 v[176:179], v5, s[20:23], s99 offen offset:0 nt
  v_mfma_f32_16x16x32_bf16 v[24:27], a[228:231], v[36:39], v[24:27]
  v_mfma_f32_16x16x32_bf16 v[24:27], a[232:235], v[40:43], v[24:27]
  v_mfma_f32_16x16x32_bf16 v[24:27], a[236:239], v[44:47], v[24:27]
  v_mov_b32_dpp v52, v28 quad_perm:[0,0,0,0] row_mask:0xf bank_mask:0xf
  v_add_f32_dpp v52, v29, v52 quad_perm:[1,1,1,1] row_mask:0xf bank_mask:0xf
  v_add_f32_dpp v52, v30, v52 quad_perm:[2,2,2,2] row_mask:0xf bank_mask:0xf
  v_add_f32_dpp v52, v31, v52 quad_perm:[3,3,3,3] row_mask:0xf bank_mask:0xf
  v_cndmask_b32 v51, v51, v52, s[70:71]
  v_mfma_f32_16x16x32_bf16 v[28:31], a[240:243], v[32:35], 0
  v_mfma_f32_16x16x32_bf16 v[28:31], a[244:247], v[36:39], v[28:31]
  v_mfma_f32_16x16x32_bf16 v[28:31], a[248:251], v[40:43], v[28:31]
  v_mfma_f32_16x16x32_bf16 v[28:31], a[252:255], v[44:47], v[28:31]
  v_mov_b32_dpp v52, v24 quad_perm:[0,0,0,0] row_mask:0xf bank_mask:0xf
  v_add_f32_dpp v52, v25, v52 quad_perm:[1,1,1,1] row_mask:0xf bank_mask:0xf
  v_add_f32_dpp v52, v26, v52 quad_perm:[2,2,2,2] row_mask:0xf bank_mask:0xf
  v_add_f32_dpp v52, v27, v52 quad_perm:[3,3,3,3] row_mask:0xf bank_mask:0xf
  v_cndmask_b32 v51, v51, v52, s[72:73]
  s_nop 3
  v_mov_b32_dpp v52, v28 quad_perm:[0,0,0,0] row_mask:0xf bank_mask:0xf
  v_add_f32_dpp v52, v29, v52 quad_perm:[1,1,1,1] row_mask:0xf bank_mask:0xf
  v_add_f32_dpp v52, v30, v52 quad_perm:[2,2,2,2] row_mask:0xf bank_mask:0xf
  v_add_f32_dpp v52, v31, v52 quad_perm:[3,3,3,3] row_mask:0xf bank_mask:0xf
  v_cndmask_b32 v51, v51, v52, s[74:75]
  v_cvt_pk_bf16_f32 v52, v48, v49
  v_lshlrev_b32 v54, 16, v52
  v_and_b32 v55, 0xffff0000, v52
  v_mul_f32 v54, 0x3db504f3, v54
  v_mul_f32 v55, 0x3db504f3, v55
  v_cvt_pk_bf16_f32 v52, v54, v55
  v_lshlrev_b32 v54, 16, v52
  s_waitcnt vmcnt(7)
  s_mov_b32 s65, 6144
  buffer_load_dwordx4 v[232:235], v63, s[12:15], s65 offen nt
  v_and_b32 v55, 0xffff0000, v52
  v_cvt_pk_bf16_f32 v52, v50, v51
  v_lshlrev_b32 v56, 16, v52
  v_and_b32 v57, 0xffff0000, v52
  v_mul_f32 v56, 0x3db504f3, v56
  v_mul_f32 v57, 0x3db504f3, v57
  v_cvt_pk_bf16_f32 v52, v56, v57
  v_lshlrev_b32 v56, 16, v52
  v_and_b32 v57, 0xffff0000, v52
  v_max_f32 v58, v54, v55
  v_max3_f32 v58, v58, v56, v57
  s_nop 1
  v_max_f32_dpp v58, v58, v58 quad_perm:[1,0,3,2] row_mask:0xf bank_mask:0xf
  s_nop 1
  v_max_f32_dpp v58, v58, v58 quad_perm:[2,3,0,1] row_mask:0xf bank_mask:0xf
  s_nop 1
  v_max_f32_dpp v58, v58, v58 row_half_mirror row_mask:0xf bank_mask:0xf
  s_nop 1
  v_max_f32_dpp v58, v58, v58 row_mirror row_mask:0xf bank_mask:0xf
  v_mov_b32 v52, v58
  s_nop 1
  v_permlane16_swap_b32 v58, v52
  s_nop 0
  v_max_f32 v58, v58, v52
  v_mov_b32 v52, v58
  s_nop 1
  v_permlane32_swap_b32 v58, v52
  s_nop 0
  v_max_f32 v58, v58, v52
  v_sub_f32 v48, v54, v58
  v_mul_f32 v48, 0x3fb8aa3b, v48
  v_exp_f32 v48, v48
  v_sub_f32 v49, v55, v58
  v_mul_f32 v49, 0x3fb8aa3b, v49
  v_exp_f32 v49, v49
  v_sub_f32 v50, v56, v58
  v_mul_f32 v50, 0x3fb8aa3b, v50
  v_exp_f32 v50, v50
  s_waitcnt vmcnt(7)
  s_mov_b32 s65, 7168
  buffer_load_dwordx4 v[236:239], v63, s[12:15], s65 offen nt
  v_sub_f32 v51, v57, v58
  v_mul_f32 v51, 0x3fb8aa3b, v51
  v_exp_f32 v51, v51
  s_nop 0
  v_add_f32 v59, v48, v49
  v_add_f32 v52, v50, v51
  v_add_f32 v59, v59, v52
  s_nop 1
  v_add_f32_dpp v59, v59, v59 quad_perm:[1,0,3,2] row_mask:0xf bank_mask:0xf
  s_nop 1
  v_add_f32_dpp v59, v59, v59 quad_perm:[2,3,0,1] row_mask:0xf bank_mask:0xf
  s_nop 1
  v_add_f32_dpp v59, v59, v59 row_half_mirror row_mask:0xf bank_mask:0xf
  s_nop 1
  v_add_f32_dpp v59, v59, v59 row_mirror row_mask:0xf bank_mask:0xf
  v_mov_b32 v52, v59
  s_nop 1
  v_permlane16_swap_b32 v59, v52
  s_nop 0
  v_add_f32 v59, v59, v52
  v_mov_b32 v52, v59
  s_nop 1
  v_permlane32_swap_b32 v59, v52
  s_nop 0
  v_add_f32 v59, v59, v52
  s_lshl_b32 s7, s3, 3
  v_mov_b32 v52, s7
  ds_write_b64 v52, v[58:59] offset:2048
  s_mov_b32 s65, 32768
  buffer_load_dwordx4 v[240:243], v63, s[12:15], s65 offen nt
  s_waitcnt lgkmcnt(0)
  s_barrier
  v_mov_b32 v52, 0
  ds_read_b128 v[64:67], v52 offset:2048
  ds_read_b128 v[68:71], v52 offset:2064
  s_waitcnt lgkmcnt(0)
  v_max_f32 v58, v64, v66
  v_max3_f32 v58, v58, v68, v70
  v_sub_f32 v64, v64, v58
  s_waitcnt vmcnt(7)
  s_mov_b32 s99, 20480
  buffer_load_dwordx4 v[184:187], v5, s[20:23], s99 offen offset:256 nt
  v_mul_f32 v64, 0x3fb8aa3b, v64
  v_exp_f32 v64, v64
  v_sub_f32 v66, v66, v58
  v_mul_f32 v66, 0x3fb8aa3b, v66
  v_exp_f32 v66, v66
  v_sub_f32 v68, v68, v58
  v_mul_f32 v68, 0x3fb8aa3b, v68
  v_exp_f32 v68, v68
  v_sub_f32 v70, v70, v58
  v_mul_f32 v70, 0x3fb8aa3b, v70
  v_exp_f32 v70, v70
  v_sub_f32 v48, v54, v58
  v_mul_f32 v48, 0x3fb8aa3b, v48
  v_exp_f32 v48, v48
  v_sub_f32 v49, v55, v58
  v_mul_f32 v49, 0x3fb8aa3b, v49
  v_exp_f32 v49, v49
  v_sub_f32 v50, v56, v58
  v_mul_f32 v50, 0x3fb8aa3b, v50
  v_exp_f32 v50, v50
  v_sub_f32 v51, v57, v58
  v_mul_f32 v51, 0x3fb8aa3b, v51
  v_exp_f32 v51, v51
  v_mul_f32 v59, v64, v65
  v_fmac_f32 v59, v66, v67
  v_fmac_f32 v59, v68, v69
  v_fmac_f32 v59, v70, v71
  v_rcp_f32 v59, v59
  s_nop 0
  v_mul_f32 v48, v48, v59
  v_mul_f32 v49, v49, v59
  v_mul_f32 v50, v50, v59
  v_mul_f32 v51, v51, v59
  v_cvt_pk_bf16_f32 v48, v48, v48
  v_cvt_pk_bf16_f32 v49, v49, v49
  v_cvt_pk_bf16_f32 v50, v50, v50
  v_cvt_pk_bf16_f32 v51, v51, v51
  s_and_b32 s70, s2, 7
  s_lshr_b32 s71, s2, 3
  s_min_u32 s72, s70, 3
  s_mul_i32 s73, s70, 3
  s_add_u32 s73, s73, s72
  s_cmp_lt_u32 s70, 3
  s_cselect_b32 s72, 4, 3
  s_sub_u32 s7, s5, 6
  s_cmp_eq_u32 s3, 2
  s_cselect_b32 s7, s7, s5
  s_lshr_b32 s78, s7, 1
  s_lshl_b32 s78, s78, 7
  s_and_b32 s74, s7, 1
  s_add_u32 s78, s78, s74
  s_add_u32 s78, s78, 98304
  s_add_u32 s7, s7, 8
  s_cmp_eq_u32 s3, 0
  s_cselect_b32 s74, s70, s7
  s_lshl_b32 s74, s74, 7
  s_add_u32 s74, s74, 94208
  s_lshl_b32 s67, s5, 12
  s_mov_b32 s76, 1
  s_mov_b32 s68, 0x88888888
  s_mov_b32 s69, 0x88888888
  s_mul_i32 s7, s3, 5120
  v_add_u32 v15, s7, v90
  v_mov_b32 v14, v4
  s_and_b32 s75, s71, 7
  s_lshl_b32 s7, s70, 3
  s_add_u32 s75, s75, s7
  s_lshl_b32 s75, s75, 9
  s_add_u32 s75, s75, 196608
  v_bfe_u32 v52, v0, 2, 1
  v_mul_u32_u24 v61, 0xffff, v52
  v_xor_b32 v60, 0xffff, v61
  v_and_b32 v52, 3, v0
  v_mul_u32_u24 v62, 0x5555, v52
  v_lshlrev_b32 v12, 9, v1
  v_add_u32 v54, 0, v15
  v_add_u32 v55, 1024, v15
  v_add_u32 v56, 2048, v15
  v_add_u32 v57, 3072, v15
  v_add_u32 v58, 4096, v15
  v_mov_b32 v64, 0
  v_mov_b32 v65, 0
  v_mov_b32 v66, 0
  v_mov_b32 v67, 0
  v_mov_b32 v68, 0
  v_mov_b32 v69, 0
  v_mov_b32 v70, 0
  v_mov_b32 v71, 0
  v_mov_b32 v72, 0
  v_mov_b32 v73, 0
  v_mov_b32 v74, 0
  v_mov_b32 v75, 0
  v_mov_b32 v76, 0
  v_mov_b32 v77, 0
  v_mov_b32 v78, 0
  v_mov_b32 v79, 0
  v_mov_b32 v80, 0
  v_mov_b32 v81, 0
  v_mov_b32 v82, 0
  v_mov_b32 v83, 0
  v_and_b32_dpp v16, v48, v8 row_newbcast:0 row_mask:0xf bank_mask:0xf
  v_and_b32_dpp v17, v48, v9 row_newbcast:0 row_mask:0xf bank_mask:0xf
  v_and_b32_dpp v18, v48, v10 row_newbcast:0 row_mask:0xf bank_mask:0xf
  v_and_b32_dpp v19, v48, v11 row_newbcast:0 row_mask:0xf bank_mask:0xf
  s_nop 1
  v_mfma_f32_16x16x32_bf16 v[24:27], v[208:211], v[16:19], 0
  v_and_b32_dpp v20, v48, v8 row_newbcast:4 row_mask:0xf bank_mask:0xf
  v_and_b32_dpp v21, v48, v9 row_newbcast:4 row_mask:0xf bank_mask:0xf
  v_and_b32_dpp v22, v48, v10 row_newbcast:4 row_mask:0xf bank_mask:0xf
  v_and_b32_dpp v23, v48, v11 row_newbcast:4 row_mask:0xf bank_mask:0xf
  s_nop 1
  v_mfma_f32_16x16x32_bf16 v[24:27], v[212:215], v[20:23], v[24:27]
  v_and_b32_dpp v16, v48, v8 row_newbcast:8 row_mask:0xf bank_mask:0xf
  v_and_b32_dpp v17, v48, v9 row_newbcast:8 row_mask:0xf bank_mask:0xf
  v_and_b32_dpp v18, v48, v10 row_newbcast:8 row_mask:0xf bank_mask:0xf
  v_and_b32_dpp v19, v48, v11 row_newbcast:8 row_mask:0xf bank_mask:0xf
  s_nop 1
  v_mfma_f32_16x16x32_bf16 v[24:27], v[216:219], v[16:19], v[24:27]
  s_waitcnt vmcnt(7)
  s_mov_b32 s65, 33792
  buffer_load_dwordx4 v[244:247], v63, s[12:15], s65 offen nt
  v_and_b32_dpp v20, v48, v8 row_newbcast:12 row_mask:0xf bank_mask:0xf
  v_and_b32_dpp v21, v48, v9 row_newbcast:12 row_mask:0xf bank_mask:0xf
  v_and_b32_dpp v22, v48, v10 row_newbcast:12 row_mask:0xf bank_mask:0xf
  v_and_b32_dpp v23, v48, v11 row_newbcast:12 row_mask:0xf bank_mask:0xf
  s_nop 1
  v_mfma_f32_16x16x32_bf16 v[24:27], v[220:223], v[20:23], v[24:27]
  v_and_b32_dpp v16, v48, v8 row_newbcast:1 row_mask:0xf bank_mask:0xf
  v_and_b32_dpp v17, v48, v9 row_newbcast:1 row_mask:0xf bank_mask:0xf
  v_and_b32_dpp v18, v48, v10 row_newbcast:1 row_mask:0xf bank_mask:0xf
  v_and_b32_dpp v19, v48, v11 row_newbcast:1 row_mask:0xf bank_mask:0xf
  s_waitcnt vmcnt(7)
  s_nop 0
  v_mfma_f32_16x16x32_bf16 v[24:27], v[224:227], v[16:19], v[24:27]
  s_mov_b32 s65, 34816
  buffer_load_dwordx4 v[248:251], v63, s[12:15], s65 offen nt
  v_and_b32_dpp v20, v48, v8 row_newbcast:5 row_mask:0xf bank_mask:0xf
  v_and_b32_dpp v21, v48, v9 row_newbcast:5 row_mask:0xf bank_mask:0xf
  v_and_b32_dpp v22, v48, v10 row_newbcast:5 row_mask:0xf bank_mask:0xf
  v_and_b32_dpp v23, v48, v11 row_newbcast:5 row_mask:0xf bank_mask:0xf
  s_waitcnt vmcnt(7)
  s_nop 0
  v_mfma_f32_16x16x32_bf16 v[24:27], v[228:231], v[20:23], v[24:27]
  s_mov_b32 s99, 20480
  buffer_load_dwordx4 v[192:195], v5, s[20:23], s99 offen offset:512 nt
  s_waitcnt vmcnt(7)
  s_mov_b32 s65, 35840
  buffer_load_dwordx4 v[252:255], v63, s[12:15], s65 offen nt
  v_and_b32_dpp v16, v48, v8 row_newbcast:9 row_mask:0xf bank_mask:0xf
  v_and_b32_dpp v17, v48, v9 row_newbcast:9 row_mask:0xf bank_mask:0xf
  v_and_b32_dpp v18, v48, v10 row_newbcast:9 row_mask:0xf bank_mask:0xf
  v_and_b32_dpp v19, v48, v11 row_newbcast:9 row_mask:0xf bank_mask:0xf
  s_waitcnt vmcnt(7)
  s_nop 0
  v_mfma_f32_16x16x32_bf16 v[24:27], v[232:235], v[16:19], v[24:27]
  s_mov_b32 s65, 36864
  buffer_load_dwordx4 a[0:3], v63, s[12:15], s65 offen nt
  v_and_b32_dpp v20, v48, v8 row_newbcast:13 row_mask:0xf bank_mask:0xf
  v_and_b32_dpp v21, v48, v9 row_newbcast:13 row_mask:0xf bank_mask:0xf
  v_and_b32_dpp v22, v48, v10 row_newbcast:13 row_mask:0xf bank_mask:0xf
  v_and_b32_dpp v23, v48, v11 row_newbcast:13 row_mask:0xf bank_mask:0xf
  s_waitcnt vmcnt(7)
  s_nop 0
  v_mfma_f32_16x16x32_bf16 v[24:27], v[236:239], v[20:23], v[24:27]
  s_mov_b32 s99, 20480
  buffer_load_dwordx4 v[200:203], v5, s[20:23], s99 offen offset:768 nt
  v_and_b32_dpp v16, v48, v8 row_newbcast:2 row_mask:0xf bank_mask:0xf
  v_and_b32_dpp v17, v48, v9 row_newbcast:2 row_mask:0xf bank_mask:0xf
  v_and_b32_dpp v18, v48, v10 row_newbcast:2 row_mask:0xf bank_mask:0xf
  v_and_b32_dpp v19, v48, v11 row_newbcast:2 row_mask:0xf bank_mask:0xf
  s_waitcnt vmcnt(7)
  s_nop 0
  v_mfma_f32_16x16x32_bf16 v[24:27], v[240:243], v[16:19], v[24:27]
  s_mov_b32 s65, 37888
  buffer_load_dwordx4 a[4:7], v63, s[12:15], s65 offen nt
  s_mov_b32 s65, 38912
  buffer_load_dwordx4 a[8:11], v63, s[12:15], s65 offen nt
  s_mov_b32 s99, 20480
  buffer_load_dwordx4 v[208:211], v5, s[20:23], s99 offen offset:1024 nt
  s_waitcnt vmcnt(9)
  s_mov_b32 s65, 39936
  buffer_load_dwordx4 a[12:15], v63, s[12:15], s65 offen nt
  v_and_b32_dpp v20, v48, v8 row_newbcast:6 row_mask:0xf bank_mask:0xf
  v_and_b32_dpp v21, v48, v9 row_newbcast:6 row_mask:0xf bank_mask:0xf
  v_and_b32_dpp v22, v48, v10 row_newbcast:6 row_mask:0xf bank_mask:0xf
  v_and_b32_dpp v23, v48, v11 row_newbcast:6 row_mask:0xf bank_mask:0xf
  s_waitcnt vmcnt(9)
  s_nop 0
  v_mfma_f32_16x16x32_bf16 v[24:27], v[244:247], v[20:23], v[24:27]
  s_mov_b32 s65, 65536
  buffer_load_dwordx4 a[16:19], v63, s[12:15], s65 offen nt
  v_and_b32_dpp v16, v48, v8 row_newbcast:10 row_mask:0xf bank_mask:0xf
  v_and_b32_dpp v17, v48, v9 row_newbcast:10 row_mask:0xf bank_mask:0xf
  v_and_b32_dpp v18, v48, v10 row_newbcast:10 row_mask:0xf bank_mask:0xf
  v_and_b32_dpp v19, v48, v11 row_newbcast:10 row_mask:0xf bank_mask:0xf
  s_waitcnt vmcnt(9)
  s_nop 0
  v_mfma_f32_16x16x32_bf16 v[24:27], v[248:251], v[16:19], v[24:27]
  s_mov_b32 s65, 66560
  buffer_load_dwordx4 a[20:23], v63, s[12:15], s65 offen nt
  s_waitcnt vmcnt(9)
  s_mov_b32 s99, 25600
  buffer_load_dwordx4 v[180:183], v5, s[20:23], s99 offen offset:0 nt
  v_and_b32_dpp v20, v48, v8 row_newbcast:14 row_mask:0xf bank_mask:0xf
  v_and_b32_dpp v21, v48, v9 row_newbcast:14 row_mask:0xf bank_mask:0xf
  v_and_b32_dpp v22, v48, v10 row_newbcast:14 row_mask:0xf bank_mask:0xf
  v_and_b32_dpp v23, v48, v11 row_newbcast:14 row_mask:0xf bank_mask:0xf
  s_waitcnt vmcnt(9)
  s_nop 0
  v_mfma_f32_16x16x32_bf16 v[24:27], v[252:255], v[20:23], v[24:27]
  s_mov_b32 s65, 67584
  buffer_load_dwordx4 a[24:27], v63, s[12:15], s65 offen nt
  v_and_b32_dpp v16, v48, v8 row_newbcast:3 row_mask:0xf bank_mask:0xf
  v_and_b32_dpp v17, v48, v9 row_newbcast:3 row_mask:0xf bank_mask:0xf
  v_and_b32_dpp v18, v48, v10 row_newbcast:3 row_mask:0xf bank_mask:0xf
  v_and_b32_dpp v19, v48, v11 row_newbcast:3 row_mask:0xf bank_mask:0xf
  s_waitcnt vmcnt(9)
  s_nop 0
  v_mfma_f32_16x16x32_bf16 v[24:27], a[0:3], v[16:19], v[24:27]
  s_mov_b32 s65, 68608
  buffer_load_dwordx4 a[28:31], v63, s[12:15], s65 offen nt
  s_waitcnt vmcnt(9)
  s_mov_b32 s99, 25600
  buffer_load_dwordx4 v[188:191], v5, s[20:23], s99 offen offset:256 nt
  v_and_b32_dpp v20, v48, v8 row_newbcast:7 row_mask:0xf bank_mask:0xf
  v_and_b32_dpp v21, v48, v9 row_newbcast:7 row_mask:0xf bank_mask:0xf
  v_and_b32_dpp v22, v48, v10 row_newbcast:7 row_mask:0xf bank_mask:0xf
  v_and_b32_dpp v23, v48, v11 row_newbcast:7 row_mask:0xf bank_mask:0xf
  s_waitcnt vmcnt(9)
  s_nop 0
  v_mfma_f32_16x16x32_bf16 v[24:27], a[4:7], v[20:23], v[24:27]
  s_mov_b32 s65, 69632
  buffer_load_dwordx4 a[32:35], v63, s[12:15], s65 offen nt
  v_and_b32_dpp v16, v48, v8 row_newbcast:11 row_mask:0xf bank_mask:0xf
  v_and_b32_dpp v17, v48, v9 row_newbcast:11 row_mask:0xf bank_mask:0xf
  v_and_b32_dpp v18, v48, v10 row_newbcast:11 row_mask:0xf bank_mask:0xf
  v_and_b32_dpp v19, v48, v11 row_newbcast:11 row_mask:0xf bank_mask:0xf
  s_waitcnt vmcnt(9)
  s_nop 0
  v_mfma_f32_16x16x32_bf16 v[24:27], a[8:11], v[16:19], v[24:27]
  s_mov_b32 s65, 70656
  buffer_load_dwordx4 a[36:39], v63, s[12:15], s65 offen nt
  s_waitcnt vmcnt(9)
  s_mov_b32 s99, 25600
  buffer_load_dwordx4 v[196:199], v5, s[20:23], s99 offen offset:512 nt
  v_and_b32_dpp v20, v48, v8 row_newbcast:15 row_mask:0xf bank_mask:0xf
  v_and_b32_dpp v21, v48, v9 row_newbcast:15 row_mask:0xf bank_mask:0xf
  v_and_b32_dpp v22, v48, v10 row_newbcast:15 row_mask:0xf bank_mask:0xf
  v_and_b32_dpp v23, v48, v11 row_newbcast:15 row_mask:0xf bank_mask:0xf
  s_waitcnt vmcnt(9)
  s_nop 0
  v_mfma_f32_16x16x32_bf16 v[24:27], a[12:15], v[20:23], v[24:27]
  s_mov_b32 s65, 71680
  buffer_load_dwordx4 a[40:43], v63, s[12:15], s65 offen nt
  v_and_b32_dpp v16, v49, v8 row_newbcast:0 row_mask:0xf bank_mask:0xf
  v_and_b32_dpp v17, v49, v9 row_newbcast:0 row_mask:0xf bank_mask:0xf
  v_and_b32_dpp v18, v49, v10 row_newbcast:0 row_mask:0xf bank_mask:0xf
  v_and_b32_dpp v19, v49, v11 row_newbcast:0 row_mask:0xf bank_mask:0xf
  s_waitcnt vmcnt(9)
  s_nop 0
  v_mfma_f32_16x16x32_bf16 v[24:27], a[16:19], v[16:19], v[24:27]
  s_mov_b32 s65, 72704
  buffer_load_dwordx4 a[44:47], v63, s[12:15], s65 offen nt
  v_and_b32_dpp v20, v49, v8 row_newbcast:4 row_mask:0xf bank_mask:0xf
  v_and_b32_dpp v21, v49, v9 row_newbcast:4 row_mask:0xf bank_mask:0xf
  v_and_b32_dpp v22, v49, v10 row_newbcast:4 row_mask:0xf bank_mask:0xf
  v_and_b32_dpp v23, v49, v11 row_newbcast:4 row_mask:0xf bank_mask:0xf
  s_waitcnt vmcnt(9)
  s_nop 0
  v_mfma_f32_16x16x32_bf16 v[24:27], a[20:23], v[20:23], v[24:27]
  s_mov_b32 s99, 25600
  buffer_load_dwordx4 v[204:207], v5, s[20:23], s99 offen offset:768 nt
  s_waitcnt vmcnt(9)
  s_mov_b32 s65, 98304
  buffer_load_dwordx4 a[48:51], v63, s[12:15], s65 offen nt
  v_and_b32_dpp v16, v49, v8 row_newbcast:8 row_mask:0xf bank_mask:0xf
  v_and_b32_dpp v17, v49, v9 row_newbcast:8 row_mask:0xf bank_mask:0xf
  v_and_b32_dpp v18, v49, v10 row_newbcast:8 row_mask:0xf bank_mask:0xf
  v_and_b32_dpp v19, v49, v11 row_newbcast:8 row_mask:0xf bank_mask:0xf
  s_waitcnt vmcnt(9)
  s_nop 0
  v_mfma_f32_16x16x32_bf16 v[24:27], a[24:27], v[16:19], v[24:27]
  s_mov_b32 s65, 99328
  buffer_load_dwordx4 a[52:55], v63, s[12:15], s65 offen nt
  v_and_b32_dpp v20, v49, v8 row_newbcast:12 row_mask:0xf bank_mask:0xf
  v_and_b32_dpp v21, v49, v9 row_newbcast:12 row_mask:0xf bank_mask:0xf
  v_and_b32_dpp v22, v49, v10 row_newbcast:12 row_mask:0xf bank_mask:0xf
  v_and_b32_dpp v23, v49, v11 row_newbcast:12 row_mask:0xf bank_mask:0xf
  s_waitcnt vmcnt(9)
  s_nop 0
  v_mfma_f32_16x16x32_bf16 v[24:27], a[28:31], v[20:23], v[24:27]
  s_mov_b32 s65, 100352
  buffer_load_dwordx4 a[56:59], v63, s[12:15], s65 offen nt
  s_waitcnt vmcnt(9)
  s_mov_b32 s99, 25600
  buffer_load_dwordx4 v[212:215], v5, s[20:23], s99 offen offset:1024 nt
  v_and_b32_dpp v16, v49, v8 row_newbcast:1 row_mask:0xf bank_mask:0xf
  v_and_b32_dpp v17, v49, v9 row_newbcast:1 row_mask:0xf bank_mask:0xf
  v_and_b32_dpp v18, v49, v10 row_newbcast:1 row_mask:0xf bank_mask:0xf
  v_and_b32_dpp v19, v49, v11 row_newbcast:1 row_mask:0xf bank_mask:0xf
  s_waitcnt vmcnt(9)
  s_nop 0
  v_mfma_f32_16x16x32_bf16 v[24:27], a[32:35], v[16:19], v[24:27]
  s_mov_b32 s65, 101376
  buffer_load_dwordx4 a[60:63], v63, s[12:15], s65 offen nt
  v_and_b32_dpp v20, v49, v8 row_newbcast:5 row_mask:0xf bank_mask:0xf
  v_and_b32_dpp v21, v49, v9 row_newbcast:5 row_mask:0xf bank_mask:0xf
  v_and_b32_dpp v22, v49, v10 row_newbcast:5 row_mask:0xf bank_mask:0xf
  v_and_b32_dpp v23, v49, v11 row_newbcast:5 row_mask:0xf bank_mask:0xf
  s_waitcnt vmcnt(9)
  s_nop 0
  v_mfma_f32_16x16x32_bf16 v[24:27], a[36:39], v[20:23], v[24:27]
  s_mov_b32 s65, 102400
  buffer_load_dwordx4 a[64:67], v63, s[12:15], s65 offen nt
  s_waitcnt vmcnt(9)
  s_mov_b32 s99, 30720
  buffer_load_dwordx4 v[216:219], v5, s[20:23], s99 offen offset:0 nt
  v_and_b32_dpp v16, v49, v8 row_newbcast:9 row_mask:0xf bank_mask:0xf
  v_and_b32_dpp v17, v49, v9 row_newbcast:9 row_mask:0xf bank_mask:0xf
  v_and_b32_dpp v18, v49, v10 row_newbcast:9 row_mask:0xf bank_mask:0xf
  v_and_b32_dpp v19, v49, v11 row_newbcast:9 row_mask:0xf bank_mask:0xf
  s_waitcnt vmcnt(9)
  s_nop 0
  v_mfma_f32_16x16x32_bf16 v[24:27], a[40:43], v[16:19], v[24:27]
  s_mov_b32 s65, 103424
  buffer_load_dwordx4 a[68:71], v63, s[12:15], s65 offen nt
  v_and_b32_dpp v20, v49, v8 row_newbcast:13 row_mask:0xf bank_mask:0xf
  v_and_b32_dpp v21, v49, v9 row_newbcast:13 row_mask:0xf bank_mask:0xf
  v_and_b32_dpp v22, v49, v10 row_newbcast:13 row_mask:0xf bank_mask:0xf
  v_and_b32_dpp v23, v49, v11 row_newbcast:13 row_mask:0xf bank_mask:0xf
  s_waitcnt vmcnt(9)
  s_nop 0
  v_mfma_f32_16x16x32_bf16 v[24:27], a[44:47], v[20:23], v[24:27]
  s_mov_b32 s65, 104448
  buffer_load_dwordx4 a[72:75], v63, s[12:15], s65 offen nt
  s_waitcnt vmcnt(9)
  s_mov_b32 s99, 30720
  buffer_load_dwordx4 v[224:227], v5, s[20:23], s99 offen offset:256 nt
  v_and_b32_dpp v16, v49, v8 row_newbcast:2 row_mask:0xf bank_mask:0xf
  v_and_b32_dpp v17, v49, v9 row_newbcast:2 row_mask:0xf bank_mask:0xf
  v_and_b32_dpp v18, v49, v10 row_newbcast:2 row_mask:0xf bank_mask:0xf
  v_and_b32_dpp v19, v49, v11 row_newbcast:2 row_mask:0xf bank_mask:0xf
  s_waitcnt vmcnt(9)
  s_nop 0
  v_mfma_f32_16x16x32_bf16 v[24:27], a[48:51], v[16:19], v[24:27]
  s_mov_b32 s65, 105472
  buffer_load_dwordx4 a[76:79], v63, s[12:15], s65 offen nt
  v_and_b32_dpp v20, v49, v8 row_newbcast:6 row_mask:0xf bank_mask:0xf
  v_and_b32_dpp v21, v49, v9 row_newbcast:6 row_mask:0xf bank_mask:0xf
  v_and_b32_dpp v22, v49, v10 row_newbcast:6 row_mask:0xf bank_mask:0xf
  v_and_b32_dpp v23, v49, v11 row_newbcast:6 row_mask:0xf bank_mask:0xf
  s_waitcnt vmcnt(9)
  s_nop 0
  v_mfma_f32_16x16x32_bf16 v[24:27], a[52:55], v[20:23], v[24:27]
  s_mov_b32 s65, 131072
  buffer_load_dwordx4 a[80:83], v63, s[12:15], s65 offen nt
  v_and_b32_dpp v16, v49, v8 row_newbcast:10 row_mask:0xf bank_mask:0xf
  v_and_b32_dpp v17, v49, v9 row_newbcast:10 row_mask:0xf bank_mask:0xf
  v_and_b32_dpp v18, v49, v10 row_newbcast:10 row_mask:0xf bank_mask:0xf
  v_and_b32_dpp v19, v49, v11 row_newbcast:10 row_mask:0xf bank_mask:0xf
  s_waitcnt vmcnt(9)
  s_nop 0
  v_mfma_f32_16x16x32_bf16 v[24:27], a[56:59], v[16:19], v[24:27]
  s_mov_b32 s65, 132096
  buffer_load_dwordx4 a[84:87], v63, s[12:15], s65 offen nt
  s_waitcnt vmcnt(9)
  s_mov_b32 s99, 30720
  buffer_load_dwordx4 v[232:235], v5, s[20:23], s99 offen offset:512 nt
  v_and_b32_dpp v20, v49, v8 row_newbcast:14 row_mask:0xf bank_mask:0xf
  v_and_b32_dpp v21, v49, v9 row_newbcast:14 row_mask:0xf bank_mask:0xf
  v_and_b32_dpp v22, v49, v10 row_newbcast:14 row_mask:0xf bank_mask:0xf
  v_and_b32_dpp v23, v49, v11 row_newbcast:14 row_mask:0xf bank_mask:0xf
  s_waitcnt vmcnt(9)
  s_nop 0
  v_mfma_f32_16x16x32_bf16 v[24:27], a[60:63], v[20:23], v[24:27]
  s_mov_b32 s65, 133120
  buffer_load_dwordx4 a[88:91], v63, s[12:15], s65 offen nt
  v_and_b32_dpp v16, v49, v8 row_newbcast:3 row_mask:0xf bank_mask:0xf
  v_and_b32_dpp v17, v49, v9 row_newbcast:3 row_mask:0xf bank_mask:0xf
  v_and_b32_dpp v18, v49, v10 row_newbcast:3 row_mask:0xf bank_mask:0xf
  v_and_b32_dpp v19, v49, v11 row_newbcast:3 row_mask:0xf bank_mask:0xf
  s_waitcnt vmcnt(9)
  s_nop 0
  v_mfma_f32_16x16x32_bf16 v[24:27], a[64:67], v[16:19], v[24:27]
  s_mov_b32 s65, 134144
  buffer_load_dwordx4 a[92:95], v63, s[12:15], s65 offen nt
  s_waitcnt vmcnt(9)
  s_mov_b32 s99, 30720
  buffer_load_dwordx4 v[240:243], v5, s[20:23], s99 offen offset:768 nt
  v_and_b32_dpp v20, v49, v8 row_newbcast:7 row_mask:0xf bank_mask:0xf
  v_and_b32_dpp v21, v49, v9 row_newbcast:7 row_mask:0xf bank_mask:0xf
  v_and_b32_dpp v22, v49, v10 row_newbcast:7 row_mask:0xf bank_mask:0xf
  v_and_b32_dpp v23, v49, v11 row_newbcast:7 row_mask:0xf bank_mask:0xf
  s_waitcnt vmcnt(9)
  s_nop 0
  v_mfma_f32_16x16x32_bf16 v[24:27], a[68:71], v[20:23], v[24:27]
  s_mov_b32 s65, 135168
  buffer_load_dwordx4 a[96:99], v63, s[12:15], s65 offen nt
  s_load_dwordx2 s[34:35], s[60:61], 0x80
  v_and_b32_dpp v16, v49, v8 row_newbcast:11 row_mask:0xf bank_mask:0xf
  v_and_b32_dpp v17, v49, v9 row_newbcast:11 row_mask:0xf bank_mask:0xf
  v_and_b32_dpp v18, v49, v10 row_newbcast:11 row_mask:0xf bank_mask:0xf
  v_and_b32_dpp v19, v49, v11 row_newbcast:11 row_mask:0xf bank_mask:0xf
  s_waitcnt vmcnt(9)
  s_nop 0
  v_mfma_f32_16x16x32_bf16 v[24:27], a[72:75], v[16:19], v[24:27]
  s_mov_b32 s65, 136192
  buffer_load_dwordx4 a[100:103], v63, s[12:15], s65 offen nt
  s_waitcnt vmcnt(9)
  s_mov_b32 s99, 30720
  buffer_load_dwordx4 v[248:251], v5, s[20:23], s99 offen offset:1024 nt
  v_and_b32_dpp v20, v49, v8 row_newbcast:15 row_mask:0xf bank_mask:0xf
  v_and_b32_dpp v21, v49, v9 row_newbcast:15 row_mask:0xf bank_mask:0xf
  v_and_b32_dpp v22, v49, v10 row_newbcast:15 row_mask:0xf bank_mask:0xf
  v_and_b32_dpp v23, v49, v11 row_newbcast:15 row_mask:0xf bank_mask:0xf
  s_waitcnt vmcnt(9)
  s_nop 0
  v_mfma_f32_16x16x32_bf16 v[24:27], a[76:79], v[20:23], v[24:27]
  s_mov_b32 s65, 137216
  buffer_load_dwordx4 a[104:107], v63, s[12:15], s65 offen nt
  v_and_b32_dpp v16, v50, v8 row_newbcast:0 row_mask:0xf bank_mask:0xf
  v_and_b32_dpp v17, v50, v9 row_newbcast:0 row_mask:0xf bank_mask:0xf
  v_and_b32_dpp v18, v50, v10 row_newbcast:0 row_mask:0xf bank_mask:0xf
  v_and_b32_dpp v19, v50, v11 row_newbcast:0 row_mask:0xf bank_mask:0xf
  s_waitcnt vmcnt(9)
  s_nop 0
  v_mfma_f32_16x16x32_bf16 v[24:27], a[80:83], v[16:19], v[24:27]
  s_mov_b32 s65, 138240
  buffer_load_dwordx4 a[108:111], v63, s[12:15], s65 offen nt
  v_and_b32_dpp v20, v50, v8 row_newbcast:4 row_mask:0xf bank_mask:0xf
  v_and_b32_dpp v21, v50, v9 row_newbcast:4 row_mask:0xf bank_mask:0xf
  v_and_b32_dpp v22, v50, v10 row_newbcast:4 row_mask:0xf bank_mask:0xf
  v_and_b32_dpp v23, v50, v11 row_newbcast:4 row_mask:0xf bank_mask:0xf
  s_waitcnt vmcnt(9)
  s_nop 0
  v_mfma_f32_16x16x32_bf16 v[24:27], a[84:87], v[20:23], v[24:27]
  s_mov_b32 s99, 35840
  buffer_load_dwordx4 v[220:223], v5, s[20:23], s99 offen offset:0 nt
  s_waitcnt vmcnt(9)
  s_mov_b32 s65, 163840
  buffer_load_dwordx4 a[112:115], v63, s[12:15], s65 offen nt
  v_and_b32_dpp v16, v50, v8 row_newbcast:8 row_mask:0xf bank_mask:0xf
  v_and_b32_dpp v17, v50, v9 row_newbcast:8 row_mask:0xf bank_mask:0xf
  v_and_b32_dpp v18, v50, v10 row_newbcast:8 row_mask:0xf bank_mask:0xf
  v_and_b32_dpp v19, v50, v11 row_newbcast:8 row_mask:0xf bank_mask:0xf
  s_waitcnt vmcnt(9)
  s_nop 0
  v_mfma_f32_16x16x32_bf16 v[24:27], a[88:91], v[16:19], v[24:27]
  s_mov_b32 s65, 164864
  buffer_load_dwordx4 a[116:119], v63, s[12:15], s65 offen nt
  v_and_b32_dpp v20, v50, v8 row_newbcast:12 row_mask:0xf bank_mask:0xf
  v_and_b32_dpp v21, v50, v9 row_newbcast:12 row_mask:0xf bank_mask:0xf
  v_and_b32_dpp v22, v50, v10 row_newbcast:12 row_mask:0xf bank_mask:0xf
  v_and_b32_dpp v23, v50, v11 row_newbcast:12 row_mask:0xf bank_mask:0xf
  s_waitcnt vmcnt(9)
  s_nop 0
  v_mfma_f32_16x16x32_bf16 v[24:27], a[92:95], v[20:23], v[24:27]
  s_mov_b32 s65, 165888
  buffer_load_dwordx4 a[120:123], v63, s[12:15], s65 offen nt
L_ichk:
  s_waitcnt lgkmcnt(0)
  s_orn2_b32 s35, s35, 0xff
  s_and_b32 s34, s34, s35
  s_cmp_eq_u32 s34, -1
  s_cbranch_scc0 L_islow
  s_waitcnt vmcnt(9)
  s_mov_b32 s99, 35840
  buffer_load_dwordx4 v[228:231], v5, s[20:23], s99 offen offset:256 nt
  v_and_b32_dpp v16, v50, v8 row_newbcast:1 row_mask:0xf bank_mask:0xf
  v_and_b32_dpp v17, v50, v9 row_newbcast:1 row_mask:0xf bank_mask:0xf
  v_and_b32_dpp v18, v50, v10 row_newbcast:1 row_mask:0xf bank_mask:0xf
  v_and_b32_dpp v19, v50, v11 row_newbcast:1 row_mask:0xf bank_mask:0xf
  s_waitcnt vmcnt(9)
  s_nop 0
  v_mfma_f32_16x16x32_bf16 v[24:27], a[96:99], v[16:19], v[24:27]
  s_mov_b32 s65, 166912
  buffer_load_dwordx4 a[124:127], v63, s[12:15], s65 offen nt
  v_and_b32_dpp v20, v50, v8 row_newbcast:5 row_mask:0xf bank_mask:0xf
  v_and_b32_dpp v21, v50, v9 row_newbcast:5 row_mask:0xf bank_mask:0xf
  v_and_b32_dpp v22, v50, v10 row_newbcast:5 row_mask:0xf bank_mask:0xf
  v_and_b32_dpp v23, v50, v11 row_newbcast:5 row_mask:0xf bank_mask:0xf
  s_waitcnt vmcnt(9)
  s_nop 0
  v_mfma_f32_16x16x32_bf16 v[24:27], a[100:103], v[20:23], v[24:27]
  s_mov_b32 s65, 167936
  buffer_load_dwordx4 a[128:131], v63, s[12:15], s65 offen nt
  s_waitcnt vmcnt(9)
  s_mov_b32 s99, 35840
  buffer_load_dwordx4 v[236:239], v5, s[20:23], s99 offen offset:512 nt
  v_and_b32_dpp v16, v50, v8 row_newbcast:9 row_mask:0xf bank_mask:0xf
  v_and_b32_dpp v17, v50, v9 row_newbcast:9 row_mask:0xf bank_mask:0xf
  v_and_b32_dpp v18, v50, v10 row_newbcast:9 row_mask:0xf bank_mask:0xf
  v_and_b32_dpp v19, v50, v11 row_newbcast:9 row_mask:0xf bank_mask:0xf
  s_waitcnt vmcnt(9)
  s_nop 0
  v_mfma_f32_16x16x32_bf16 v[24:27], a[104:107], v[16:19], v[24:27]
  s_mov_b32 s65, 168960
  buffer_load_dwordx4 a[132:135], v63, s[12:15], s65 offen nt
  v_and_b32_dpp v20, v50, v8 row_newbcast:13 row_mask:0xf bank_mask:0xf
  v_and_b32_dpp v21, v50, v9 row_newbcast:13 row_mask:0xf bank_mask:0xf
  v_and_b32_dpp v22, v50, v10 row_newbcast:13 row_mask:0xf bank_mask:0xf
  v_and_b32_dpp v23, v50, v11 row_newbcast:13 row_mask:0xf bank_mask:0xf
  s_waitcnt vmcnt(9)
  s_nop 0
  v_mfma_f32_16x16x32_bf16 v[24:27], a[108:111], v[20:23], v[24:27]
  s_mov_b32 s65, 169984
  buffer_load_dwordx4 a[136:139], v63, s[12:15], s65 offen nt
  s_waitcnt vmcnt(9)
  s_mov_b32 s99, 35840
  buffer_load_dwordx4 v[244:247], v5, s[20:23], s99 offen offset:768 nt
  v_and_b32_dpp v16, v50, v8 row_newbcast:2 row_mask:0xf bank_mask:0xf
  v_and_b32_dpp v17, v50, v9 row_newbcast:2 row_mask:0xf bank_mask:0xf
  v_and_b32_dpp v18, v50, v10 row_newbcast:2 row_mask:0xf bank_mask:0xf
  v_and_b32_dpp v19, v50, v11 row_newbcast:2 row_mask:0xf bank_mask:0xf
  s_waitcnt vmcnt(9)
  s_nop 0
  v_mfma_f32_16x16x32_bf16 v[24:27], a[112:115], v[16:19], v[24:27]
  s_mov_b32 s65, 171008
  buffer_load_dwordx4 a[140:143], v63, s[12:15], s65 offen nt
  v_and_b32_dpp v20, v50, v8 row_newbcast:6 row_mask:0xf bank_mask:0xf
  v_and_b32_dpp v21, v50, v9 row_newbcast:6 row_mask:0xf bank_mask:0xf
  v_and_b32_dpp v22, v50, v10 row_newbcast:6 row_mask:0xf bank_mask:0xf
  v_and_b32_dpp v23, v50, v11 row_newbcast:6 row_mask:0xf bank_mask:0xf
  s_waitcnt vmcnt(9)
  s_nop 0
  v_mfma_f32_16x16x32_bf16 v[24:27], a[116:119], v[20:23], v[24:27]
  s_mov_b32 s65, 196608
  buffer_load_dwordx4 a[144:147], v63, s[12:15], s65 offen nt
  v_and_b32_dpp v16, v50, v8 row_newbcast:10 row_mask:0xf bank_mask:0xf
  v_and_b32_dpp v17, v50, v9 row_newbcast:10 row_mask:0xf bank_mask:0xf
  v_and_b32_dpp v18, v50, v10 row_newbcast:10 row_mask:0xf bank_mask:0xf
  v_and_b32_dpp v19, v50, v11 row_newbcast:10 row_mask:0xf bank_mask:0xf
  s_waitcnt vmcnt(9)
  s_nop 0
  v_mfma_f32_16x16x32_bf16 v[24:27], a[120:123], v[16:19], v[24:27]
  s_mov_b32 s99, 35840
  buffer_load_dwordx4 v[252:255], v5, s[20:23], s99 offen offset:1024 nt
  s_waitcnt vmcnt(9)
  s_mov_b32 s65, 197632
  buffer_load_dwordx4 a[148:151], v63, s[12:15], s65 offen nt
  v_and_b32_dpp v20, v50, v8 row_newbcast:14 row_mask:0xf bank_mask:0xf
  v_and_b32_dpp v21, v50, v9 row_newbcast:14 row_mask:0xf bank_mask:0xf
  v_and_b32_dpp v22, v50, v10 row_newbcast:14 row_mask:0xf bank_mask:0xf
  v_and_b32_dpp v23, v50, v11 row_newbcast:14 row_mask:0xf bank_mask:0xf
  s_waitcnt vmcnt(9)
  s_nop 0
  v_mfma_f32_16x16x32_bf16 v[24:27], a[124:127], v[20:23], v[24:27]
  s_mov_b32 s65, 198656
  buffer_load_dwordx4 a[152:155], v63, s[12:15], s65 offen nt
  v_and_b32_dpp v16, v50, v8 row_newbcast:3 row_mask:0xf bank_mask:0xf
  v_and_b32_dpp v17, v50, v9 row_newbcast:3 row_mask:0xf bank_mask:0xf
  v_and_b32_dpp v18, v50, v10 row_newbcast:3 row_mask:0xf bank_mask:0xf
  v_and_b32_dpp v19, v50, v11 row_newbcast:3 row_mask:0xf bank_mask:0xf
  s_waitcnt vmcnt(9)
  s_nop 0
  v_mfma_f32_16x16x32_bf16 v[24:27], a[128:131], v[16:19], v[24:27]
  s_mov_b32 s65, 199680
  buffer_load_dwordx4 a[156:159], v63, s[12:15], s65 offen nt
  s_waitcnt vmcnt(9)
  s_mov_b32 s65, 200704
  buffer_load_dwordx4 a[160:163], v63, s[12:15], s65 offen nt
  v_and_b32_dpp v20, v50, v8 row_newbcast:7 row_mask:0xf bank_mask:0xf
  v_and_b32_dpp v21, v50, v9 row_newbcast:7 row_mask:0xf bank_mask:0xf
  v_and_b32_dpp v22, v50, v10 row_newbcast:7 row_mask:0xf bank_mask:0xf
  v_and_b32_dpp v23, v50, v11 row_newbcast:7 row_mask:0xf bank_mask:0xf
  s_waitcnt vmcnt(9)
  s_nop 0
  v_mfma_f32_16x16x32_bf16 v[24:27], a[132:135], v[20:23], v[24:27]
  s_mov_b32 s65, 201728
  buffer_load_dwordx4 a[164:167], v63, s[12:15], s65 offen nt
  v_and_b32_dpp v16, v50, v8 row_newbcast:11 row_mask:0xf bank_mask:0xf
  v_and_b32_dpp v17, v50, v9 row_newbcast:11 row_mask:0xf bank_mask:0xf
  v_and_b32_dpp v18, v50, v10 row_newbcast:11 row_mask:0xf bank_mask:0xf
  v_and_b32_dpp v19, v50, v11 row_newbcast:11 row_mask:0xf bank_mask:0xf
  s_waitcnt vmcnt(9)
  s_nop 0
  v_mfma_f32_16x16x32_bf16 v[24:27], a[136:139], v[16:19], v[24:27]
  s_mov_b32 s65, 202752
  buffer_load_dwordx4 a[168:171], v63, s[12:15], s65 offen nt
  s_mov_b32 s64, 0
  s_mov_b32 s79, 9
  s_sub_u32 s7, s71, 24
  s_lshl_b32 s77, s72, 1
  s_cmp_lt_u32 s7, s77
  s_cbranch_scc1 L_roleH
  s_waitcnt vmcnt(9)
  s_mov_b32 s65, 203776
  buffer_load_dwordx4 a[172:175], v63, s[12:15], s65 offen nt
  v_and_b32_dpp v20, v50, v8 row_newbcast:15 row_mask:0xf bank_mask:0xf
  v_and_b32_dpp v21, v50, v9 row_newbcast:15 row_mask:0xf bank_mask:0xf
  v_and_b32_dpp v22, v50, v10 row_newbcast:15 row_mask:0xf bank_mask:0xf
  v_and_b32_dpp v23, v50, v11 row_newbcast:15 row_mask:0xf bank_mask:0xf
  s_waitcnt vmcnt(9)
  s_nop 0
  v_mfma_f32_16x16x32_bf16 v[24:27], a[140:143], v[20:23], v[24:27]
  s_mov_b32 s65, 229376
  buffer_load_dwordx4 a[176:179], v63, s[12:15], s65 offen nt
  v_and_b32_dpp v16, v51, v8 row_newbcast:0 row_mask:0xf bank_mask:0xf
  v_and_b32_dpp v17, v51, v9 row_newbcast:0 row_mask:0xf bank_mask:0xf
  v_and_b32_dpp v18, v51, v10 row_newbcast:0 row_mask:0xf bank_mask:0xf
  v_and_b32_dpp v19, v51, v11 row_newbcast:0 row_mask:0xf bank_mask:0xf
  s_waitcnt vmcnt(9)
  s_nop 0
  v_mfma_f32_16x16x32_bf16 v[24:27], a[144:147], v[16:19], v[24:27]
  s_mov_b32 s65, 230400
  buffer_load_dwordx4 a[180:183], v63, s[12:15], s65 offen nt
  s_lshl_b32 s7, s3, 5
  s_sub_u32 s7, s71, s7
  s_cmp_ge_i32 s7, 24
  s_cbranch_scc0 L_ntg1
  s_lshl_b32 s7, s70, 12
  s_add_u32 s7, s7, 163904
  v_mov_b32 v95, 1
  s_mov_b64 exec, 1
  buffer_store_dword v95, off, s[28:31], s7
  s_mov_b64 exec, -1
L_ntg1:
  s_waitcnt vmcnt(9)
  s_mov_b32 s65, 231424
  buffer_load_dwordx4 a[184:187], v63, s[12:15], s65 offen nt
  v_and_b32_dpp v20, v51, v8 row_newbcast:4 row_mask:0xf bank_mask:0xf
  v_and_b32_dpp v21, v51, v9 row_newbcast:4 row_mask:0xf bank_mask:0xf
  v_and_b32_dpp v22, v51, v10 row_newbcast:4 row_mask:0xf bank_mask:0xf
  v_and_b32_dpp v23, v51, v11 row_newbcast:4 row_mask:0xf bank_mask:0xf
  s_waitcnt vmcnt(9)
  s_nop 0
  v_mfma_f32_16x16x32_bf16 v[24:27], a[148:151], v[20:23], v[24:27]
  s_mov_b32 s65, 232448
  buffer_load_dwordx4 a[188:191], v63, s[12:15], s65 offen nt
  v_and_b32_dpp v16, v51, v8 row_newbcast:8 row_mask:0xf bank_mask:0xf
  v_and_b32_dpp v17, v51, v9 row_newbcast:8 row_mask:0xf bank_mask:0xf
  v_and_b32_dpp v18, v51, v10 row_newbcast:8 row_mask:0xf bank_mask:0xf
  v_and_b32_dpp v19, v51, v11 row_newbcast:8 row_mask:0xf bank_mask:0xf
  s_waitcnt vmcnt(9)
  s_nop 0
  v_mfma_f32_16x16x32_bf16 v[24:27], a[152:155], v[16:19], v[24:27]
  s_mov_b32 s65, 233472
  buffer_load_dwordx4 a[192:195], v63, s[12:15], s65 offen nt
  v_and_b32_dpp v20, v51, v8 row_newbcast:12 row_mask:0xf bank_mask:0xf
  v_and_b32_dpp v21, v51, v9 row_newbcast:12 row_mask:0xf bank_mask:0xf
  v_and_b32_dpp v22, v51, v10 row_newbcast:12 row_mask:0xf bank_mask:0xf
  v_and_b32_dpp v23, v51, v11 row_newbcast:12 row_mask:0xf bank_mask:0xf
  s_waitcnt vmcnt(9)
  s_nop 0
  v_mfma_f32_16x16x32_bf16 v[24:27], a[156:159], v[20:23], v[24:27]
  s_mov_b32 s65, 234496
  buffer_load_dwordx4 a[196:199], v63, s[12:15], s65 offen nt
  v_and_b32_dpp v16, v51, v8 row_newbcast:1 row_mask:0xf bank_mask:0xf
  v_and_b32_dpp v17, v51, v9 row_newbcast:1 row_mask:0xf bank_mask:0xf
  v_and_b32_dpp v18, v51, v10 row_newbcast:1 row_mask:0xf bank_mask:0xf
  v_and_b32_dpp v19, v51, v11 row_newbcast:1 row_mask:0xf bank_mask:0xf
  s_waitcnt vmcnt(9)
  s_nop 0
  v_mfma_f32_16x16x32_bf16 v[24:27], a[160:163], v[16:19], v[24:27]
  s_mov_b32 s65, 235520
  buffer_load_dwordx4 a[200:203], v63, s[12:15], s65 offen nt
  v_and_b32_dpp v20, v51, v8 row_newbcast:5 row_mask:0xf bank_mask:0xf
  v_and_b32_dpp v21, v51, v9 row_newbcast:5 row_mask:0xf bank_mask:0xf
  v_and_b32_dpp v22, v51, v10 row_newbcast:5 row_mask:0xf bank_mask:0xf
  v_and_b32_dpp v23, v51, v11 row_newbcast:5 row_mask:0xf bank_mask:0xf
  s_waitcnt vmcnt(9)
  s_nop 0
  v_mfma_f32_16x16x32_bf16 v[24:27], a[164:167], v[20:23], v[24:27]
  s_mov_b32 s65, 236544
  buffer_load_dwordx4 a[204:207], v63, s[12:15], s65 offen nt
  v_and_b32_dpp v16, v51, v8 row_newbcast:9 row_mask:0xf bank_mask:0xf
  v_and_b32_dpp v17, v51, v9 row_newbcast:9 row_mask:0xf bank_mask:0xf
  v_and_b32_dpp v18, v51, v10 row_newbcast:9 row_mask:0xf bank_mask:0xf
  v_and_b32_dpp v19, v51, v11 row_newbcast:9 row_mask:0xf bank_mask:0xf
  s_waitcnt vmcnt(9)
  s_nop 0
  v_mfma_f32_16x16x32_bf16 v[24:27], a[168:171], v[16:19], v[24:27]
  v_and_b32_dpp v20, v51, v8 row_newbcast:13 row_mask:0xf bank_mask:0xf
  v_and_b32_dpp v21, v51, v9 row_newbcast:13 row_mask:0xf bank_mask:0xf
  v_and_b32_dpp v22, v51, v10 row_newbcast:13 row_mask:0xf bank_mask:0xf
  v_and_b32_dpp v23, v51, v11 row_newbcast:13 row_mask:0xf bank_mask:0xf
  s_waitcnt vmcnt(8)
  s_nop 0
  v_mfma_f32_16x16x32_bf16 v[24:27], a[172:175], v[20:23], v[24:27]
  v_and_b32_dpp v16, v51, v8 row_newbcast:2 row_mask:0xf bank_mask:0xf
  v_and_b32_dpp v17, v51, v9 row_newbcast:2 row_mask:0xf bank_mask:0xf
  v_and_b32_dpp v18, v51, v10 row_newbcast:2 row_mask:0xf bank_mask:0xf
  v_and_b32_dpp v19, v51, v11 row_newbcast:2 row_mask:0xf bank_mask:0xf
  s_waitcnt vmcnt(7)
  s_nop 0
  v_mfma_f32_16x16x32_bf16 v[24:27], a[176:179], v[16:19], v[24:27]
  v_and_b32_dpp v20, v51, v8 row_newbcast:6 row_mask:0xf bank_mask:0xf
  v_and_b32_dpp v21, v51, v9 row_newbcast:6 row_mask:0xf bank_mask:0xf
  v_and_b32_dpp v22, v51, v10 row_newbcast:6 row_mask:0xf bank_mask:0xf
  v_and_b32_dpp v23, v51, v11 row_newbcast:6 row_mask:0xf bank_mask:0xf
  s_waitcnt vmcnt(6)
  s_nop 0
  v_mfma_f32_16x16x32_bf16 v[24:27], a[180:183], v[20:23], v[24:27]
  v_and_b32_dpp v16, v51, v8 row_newbcast:10 row_mask:0xf bank_mask:0xf
  v_and_b32_dpp v17, v51, v9 row_newbcast:10 row_mask:0xf bank_mask:0xf
  v_and_b32_dpp v18, v51, v10 row_newbcast:10 row_mask:0xf bank_mask:0xf
  v_and_b32_dpp v19, v51, v11 row_newbcast:10 row_mask:0xf bank_mask:0xf
  s_waitcnt vmcnt(5)
  s_nop 0
  v_mfma_f32_16x16x32_bf16 v[24:27], a[184:187], v[16:19], v[24:27]
  v_and_b32_dpp v20, v51, v8 row_newbcast:14 row_mask:0xf bank_mask:0xf
  v_and_b32_dpp v21, v51, v9 row_newbcast:14 row_mask:0xf bank_mask:0xf
  v_and_b32_dpp v22, v51, v10 row_newbcast:14 row_mask:0xf bank_mask:0xf
  v_and_b32_dpp v23, v51, v11 row_newbcast:14 row_mask:0xf bank_mask:0xf
  s_waitcnt vmcnt(4)
  s_nop 0
  v_mfma_f32_16x16x32_bf16 v[24:27], a[188:191], v[20:23], v[24:27]
  s_bitcmp1_b32 9, s3
  s_cbranch_scc0 L_tkN
  s_atomic_add s76, s[62:63], s74 glc
L_tkN:
  v_and_b32_dpp v16, v51, v8 row_newbcast:3 row_mask:0xf bank_mask:0xf
  v_and_b32_dpp v17, v51, v9 row_newbcast:3 row_mask:0xf bank_mask:0xf
  v_and_b32_dpp v18, v51, v10 row_newbcast:3 row_mask:0xf bank_mask:0xf
  v_and_b32_dpp v19, v51, v11 row_newbcast:3 row_mask:0xf bank_mask:0xf
  s_waitcnt vmcnt(3)
  s_nop 0
  v_mfma_f32_16x16x32_bf16 v[24:27], a[192:195], v[16:19], v[24:27]
  v_and_b32_dpp v20, v51, v8 row_newbcast:7 row_mask:0xf bank_mask:0xf
  v_and_b32_dpp v21, v51, v9 row_newbcast:7 row_mask:0xf bank_mask:0xf
  v_and_b32_dpp v22, v51, v10 row_newbcast:7 row_mask:0xf bank_mask:0xf
  v_and_b32_dpp v23, v51, v11 row_newbcast:7 row_mask:0xf bank_mask:0xf
  s_waitcnt vmcnt(2)
  s_nop 0
  v_mfma_f32_16x16x32_bf16 v[24:27], a[196:199], v[20:23], v[24:27]
  v_and_b32_dpp v16, v51, v8 row_newbcast:11 row_mask:0xf bank_mask:0xf
  v_and_b32_dpp v17, v51, v9 row_newbcast:11 row_mask:0xf bank_mask:0xf
  v_and_b32_dpp v18, v51, v10 row_newbcast:11 row_mask:0xf bank_mask:0xf
  v_and_b32_dpp v19, v51, v11 row_newbcast:11 row_mask:0xf bank_mask:0xf
  s_waitcnt vmcnt(1)
  s_nop 0
  v_mfma_f32_16x16x32_bf16 v[24:27], a[200:203], v[16:19], v[24:27]
  v_and_b32_dpp v20, v51, v8 row_newbcast:15 row_mask:0xf bank_mask:0xf
  v_and_b32_dpp v21, v51, v9 row_newbcast:15 row_mask:0xf bank_mask:0xf
  v_and_b32_dpp v22, v51, v10 row_newbcast:15 row_mask:0xf bank_mask:0xf
  v_and_b32_dpp v23, v51, v11 row_newbcast:15 row_mask:0xf bank_mask:0xf
  s_waitcnt vmcnt(0)
  s_nop 0
  v_mfma_f32_16x16x32_bf16 v[24:27], a[204:207], v[20:23], v[24:27]
L_finN:
  s_nop 7
  ds_write_b128 v3, v[24:27] offset:2304
  ds_read_b32 v95, v84
  s_waitcnt lgkmcnt(1)
  s_barrier
  ds_read2st64_b32 v[16:17], v84 offset0:9 offset1:13
  ds_read2st64_b32 v[18:19], v84 offset0:17 offset1:21
  ds_read_b32 v95, v84
  s_waitcnt lgkmcnt(1)
  v_pk_add_f32 v[16:17], v[16:17], v[18:19]
  v_add_f32 v16, v16, v17
  v_cvt_pk_bf16_f32 v6, v16, v16
L_oproj:
  v_mov_b32 v52, 1
  s_nop 0
  v_and_b32_dpp v32, v6, v60 row_newbcast:0 row_mask:0xf bank_mask:0xf
  v_and_b32_dpp v33, v6, v61 row_newbcast:0 row_mask:0xf bank_mask:0xf
  v_and_b32_dpp v34, v6, v60 row_newbcast:4 row_mask:0xf bank_mask:0xf
  v_and_b32_dpp v35, v6, v61 row_newbcast:4 row_mask:0xf bank_mask:0xf
  v_and_b32_dpp v36, v6, v60 row_newbcast:1 row_mask:0xf bank_mask:0xf
  v_and_b32_dpp v37, v6, v61 row_newbcast:1 row_mask:0xf bank_mask:0xf
  v_smfmac_f32_16x16x64_bf16 v[64:67], v[32:35], v[96:103], v62
  v_and_b32_dpp v38, v6, v60 row_newbcast:5 row_mask:0xf bank_mask:0xf
  v_and_b32_dpp v39, v6, v61 row_newbcast:5 row_mask:0xf bank_mask:0xf
  v_smfmac_f32_16x16x64_bf16 v[68:71], v[32:35], v[104:111], v62
  v_and_b32_dpp v40, v6, v60 row_newbcast:2 row_mask:0xf bank_mask:0xf
  v_and_b32_dpp v41, v6, v61 row_newbcast:2 row_mask:0xf bank_mask:0xf
  v_smfmac_f32_16x16x64_bf16 v[64:67], v[36:39], v[136:143], v62
  v_and_b32_dpp v42, v6, v60 row_newbcast:6 row_mask:0xf bank_mask:0xf
  v_and_b32_dpp v43, v6, v61 row_newbcast:6 row_mask:0xf bank_mask:0xf
  v_smfmac_f32_16x16x64_bf16 v[68:71], v[36:39], v[144:151], v62
  v_and_b32_dpp v44, v6, v60 row_newbcast:3 row_mask:0xf bank_mask:0xf
  v_and_b32_dpp v45, v6, v61 row_newbcast:3 row_mask:0xf bank_mask:0xf
  v_smfmac_f32_16x16x64_bf16 v[64:67], v[40:43], v[176:183], v62
  v_and_b32_dpp v46, v6, v60 row_newbcast:7 row_mask:0xf bank_mask:0xf
  v_and_b32_dpp v47, v6, v61 row_newbcast:7 row_mask:0xf bank_mask:0xf
  v_smfmac_f32_16x16x64_bf16 v[68:71], v[40:43], v[184:191], v62
  s_nop 0
  v_smfmac_f32_16x16x64_bf16 v[64:67], v[44:47], v[216:223], v62
  v_smfmac_f32_16x16x64_bf16 v[68:71], v[44:47], v[224:231], v62
  v_smfmac_f32_16x16x64_bf16 v[72:75], v[32:35], v[112:119], v62
  s_waitcnt lgkmcnt(0)
  s_cmp_eq_u32 s76, 31
  v_smfmac_f32_16x16x64_bf16 v[72:75], v[36:39], v[152:159], v62
  v_smfmac_f32_16x16x64_bf16 v[72:75], v[40:43], v[192:199], v62
  ds_write_b128 v54, v[64:67] offset:6400
  v_smfmac_f32_16x16x64_bf16 v[72:75], v[44:47], v[232:239], v62
  ds_write_b128 v55, v[68:71] offset:6400
  v_smfmac_f32_16x16x64_bf16 v[76:79], v[32:35], v[120:127], v62
  v_smfmac_f32_16x16x64_bf16 v[76:79], v[36:39], v[160:167], v62
  v_smfmac_f32_16x16x64_bf16 v[76:79], v[40:43], v[200:207], v62
  v_smfmac_f32_16x16x64_bf16 v[76:79], v[44:47], v[240:247], v62
  ds_write_b128 v56, v[72:75] offset:6400
  s_cbranch_scc0 L_flagged1
  s_mov_b64 exec, 0xff
  buffer_store_byte v52, v12, s[28:31], s78 offen sc1
  s_mov_b64 exec, -1
L_flagged1:
  v_smfmac_f32_16x16x64_bf16 v[80:83], v[32:35], v[128:135], v62
  v_smfmac_f32_16x16x64_bf16 v[80:83], v[36:39], v[168:175], v62
  v_smfmac_f32_16x16x64_bf16 v[80:83], v[40:43], v[208:215], v62
  v_smfmac_f32_16x16x64_bf16 v[80:83], v[44:47], v[248:255], v62
  ds_write_b128 v57, v[76:79] offset:6400
  s_nop 6
  ds_write_b128 v58, v[80:83] offset:6400
  s_waitcnt lgkmcnt(0)
  s_barrier
  ds_read2st64_b32 v[32:33], v85 offset0:25 offset1:45
  ds_read2st64_b32 v[34:35], v85 offset0:65 offset1:85
  ds_read2st64_b32 v[36:37], v86 offset0:25 offset1:45
  ds_read2st64_b32 v[38:39], v86 offset0:65 offset1:85
  ds_read2st64_b32 v[40:41], v87 offset0:25 offset1:45
  ds_read2st64_b32 v[42:43], v87 offset0:65 offset1:85
  ds_read2st64_b32 v[44:45], v88 offset0:25 offset1:45
  ds_read2st64_b32 v[46:47], v88 offset0:65 offset1:85
  s_waitcnt lgkmcnt(6)
  v_pk_add_f32 v[32:33], v[32:33], v[34:35]
  v_add_f32 v32, v32, v33
  v_cndmask_b32 v32, v32, 1.0, s[68:69]
  buffer_atomic_add_f32 v32, v89, s[28:31], s67 offen offset:0
  s_waitcnt lgkmcnt(4)
  v_pk_add_f32 v[36:37], v[36:37], v[38:39]
  v_add_f32 v36, v36, v37
  v_cndmask_b32 v36, v36, 1.0, s[68:69]
  buffer_atomic_add_f32 v36, v89, s[28:31], s67 offen offset:1024
  s_waitcnt lgkmcnt(2)
  v_pk_add_f32 v[40:41], v[40:41], v[42:43]
  v_add_f32 v40, v40, v41
  v_cndmask_b32 v40, v40, 1.0, s[68:69]
  buffer_atomic_add_f32 v40, v89, s[28:31], s67 offen offset:2048
  s_waitcnt lgkmcnt(0)
  v_pk_add_f32 v[44:45], v[44:45], v[46:47]
  v_add_f32 v44, v44, v45
  v_cndmask_b32 v44, v44, 1.0, s[68:69]
  buffer_atomic_add_f32 v44, v89, s[28:31], s67 offen offset:3072
  s_cmp_eq_u32 s64, 0
  s_cbranch_scc0 L_guestdone
  v_mov_b32 v6, s76
  ds_write_b32 v89, v6 offset:0
  v_mov_b32 v95, 0
  s_waitcnt lgkmcnt(0)
  s_barrier
  ds_read_b32 v6, v95 offset:0
  s_waitcnt lgkmcnt(0)
  v_readfirstlane_b32 s77, v6
  s_nop 3
  s_cmp_lt_u32 s77, 10
  s_cbranch_scc1 L_roleD
  s_endpgm
L_roleH:
  buffer_load_dword v6, v14, s[28:31], s75 offen sc1
  s_waitcnt vmcnt(9)
  s_mov_b32 s65, 203776
  buffer_load_dwordx4 a[172:175], v63, s[12:15], s65 offen nt
  v_and_b32_dpp v20, v50, v8 row_newbcast:15 row_mask:0xf bank_mask:0xf
  v_and_b32_dpp v21, v50, v9 row_newbcast:15 row_mask:0xf bank_mask:0xf
  v_and_b32_dpp v22, v50, v10 row_newbcast:15 row_mask:0xf bank_mask:0xf
  v_and_b32_dpp v23, v50, v11 row_newbcast:15 row_mask:0xf bank_mask:0xf
  s_nop 1
  v_mfma_f32_16x16x32_bf16 v[24:27], a[140:143], v[20:23], v[24:27]
  s_waitcnt vmcnt(9)
  s_mov_b32 s65, 229376
  buffer_load_dwordx4 a[176:179], v63, s[12:15], s65 offen nt
  v_and_b32_dpp v16, v51, v8 row_newbcast:0 row_mask:0xf bank_mask:0xf
  v_and_b32_dpp v17, v51, v9 row_newbcast:0 row_mask:0xf bank_mask:0xf
  v_and_b32_dpp v18, v51, v10 row_newbcast:0 row_mask:0xf bank_mask:0xf
  v_and_b32_dpp v19, v51, v11 row_newbcast:0 row_mask:0xf bank_mask:0xf
  s_nop 1
  v_mfma_f32_16x16x32_bf16 v[24:27], a[144:147], v[16:19], v[24:27]
  s_waitcnt vmcnt(9)
  s_mov_b32 s65, 230400
  buffer_load_dwordx4 a[180:183], v63, s[12:15], s65 offen nt
  s_lshl_b32 s7, s3, 5
  s_sub_u32 s7, s71, s7
  s_cmp_ge_i32 s7, 24
  s_cbranch_scc0 L_ntg2
  s_lshl_b32 s7, s70, 12
  s_add_u32 s7, s7, 163904
  v_mov_b32 v95, 1
  s_mov_b64 exec, 1
  buffer_store_dword v95, off, s[28:31], s7
  s_mov_b64 exec, -1
L_ntg2:
  s_waitcnt vmcnt(9)
  s_mov_b32 s65, 231424
  buffer_load_dwordx4 a[184:187], v63, s[12:15], s65 offen nt
  v_and_b32_dpp v20, v51, v8 row_newbcast:4 row_mask:0xf bank_mask:0xf
  v_and_b32_dpp v21, v51, v9 row_newbcast:4 row_mask:0xf bank_mask:0xf
  v_and_b32_dpp v22, v51, v10 row_newbcast:4 row_mask:0xf bank_mask:0xf
  v_and_b32_dpp v23, v51, v11 row_newbcast:4 row_mask:0xf bank_mask:0xf
  s_nop 1
  v_mfma_f32_16x16x32_bf16 v[24:27], a[148:151], v[20:23], v[24:27]
  s_waitcnt vmcnt(9)
  s_mov_b32 s65, 232448
  buffer_load_dwordx4 a[188:191], v63, s[12:15], s65 offen nt
  v_and_b32_dpp v16, v51, v8 row_newbcast:8 row_mask:0xf bank_mask:0xf
  v_and_b32_dpp v17, v51, v9 row_newbcast:8 row_mask:0xf bank_mask:0xf
  v_and_b32_dpp v18, v51, v10 row_newbcast:8 row_mask:0xf bank_mask:0xf
  v_and_b32_dpp v19, v51, v11 row_newbcast:8 row_mask:0xf bank_mask:0xf
  s_nop 1
  v_mfma_f32_16x16x32_bf16 v[24:27], a[152:155], v[16:19], v[24:27]
  s_waitcnt vmcnt(9)
  s_mov_b32 s65, 233472
  buffer_load_dwordx4 a[192:195], v63, s[12:15], s65 offen nt
  v_and_b32_dpp v20, v51, v8 row_newbcast:12 row_mask:0xf bank_mask:0xf
  v_and_b32_dpp v21, v51, v9 row_newbcast:12 row_mask:0xf bank_mask:0xf
  v_and_b32_dpp v22, v51, v10 row_newbcast:12 row_mask:0xf bank_mask:0xf
  v_and_b32_dpp v23, v51, v11 row_newbcast:12 row_mask:0xf bank_mask:0xf
  s_nop 1
  v_mfma_f32_16x16x32_bf16 v[24:27], a[156:159], v[20:23], v[24:27]
  s_waitcnt vmcnt(9)
  s_mov_b32 s65, 234496
  buffer_load_dwordx4 a[196:199], v63, s[12:15], s65 offen nt
  v_and_b32_dpp v16, v51, v8 row_newbcast:1 row_mask:0xf bank_mask:0xf
  v_and_b32_dpp v17, v51, v9 row_newbcast:1 row_mask:0xf bank_mask:0xf
  v_and_b32_dpp v18, v51, v10 row_newbcast:1 row_mask:0xf bank_mask:0xf
  v_and_b32_dpp v19, v51, v11 row_newbcast:1 row_mask:0xf bank_mask:0xf
  s_nop 1
  v_mfma_f32_16x16x32_bf16 v[24:27], a[160:163], v[16:19], v[24:27]
  s_waitcnt vmcnt(9)
  s_mov_b32 s65, 235520
  buffer_load_dwordx4 a[200:203], v63, s[12:15], s65 offen nt
  v_and_b32_dpp v20, v51, v8 row_newbcast:5 row_mask:0xf bank_mask:0xf
  v_and_b32_dpp v21, v51, v9 row_newbcast:5 row_mask:0xf bank_mask:0xf
  v_and_b32_dpp v22, v51, v10 row_newbcast:5 row_mask:0xf bank_mask:0xf
  v_and_b32_dpp v23, v51, v11 row_newbcast:5 row_mask:0xf bank_mask:0xf
  s_nop 1
  v_mfma_f32_16x16x32_bf16 v[24:27], a[164:167], v[20:23], v[24:27]
  s_waitcnt vmcnt(9)
  s_mov_b32 s65, 236544
  buffer_load_dwordx4 a[204:207], v63, s[12:15], s65 offen nt
  v_and_b32_dpp v16, v51, v8 row_newbcast:9 row_mask:0xf bank_mask:0xf
  v_and_b32_dpp v17, v51, v9 row_newbcast:9 row_mask:0xf bank_mask:0xf
  v_and_b32_dpp v18, v51, v10 row_newbcast:9 row_mask:0xf bank_mask:0xf
  v_and_b32_dpp v19, v51, v11 row_newbcast:9 row_mask:0xf bank_mask:0xf
  s_nop 1
  v_mfma_f32_16x16x32_bf16 v[24:27], a[168:171], v[16:19], v[24:27]
  s_waitcnt vmcnt(9)
  s_mov_b32 s64, 1
  s_sub_u32 s67, s67, 24576
  v_cmp_eq_u32 vcc, -1, v6
  s_cbranch_vccz L_oproj
L_goslow:
  s_add_u32 s100, s100, 1
  s_cmp_gt_u32 s100, 200000
  s_cbranch_scc1 L_end
  buffer_load_dword v6, v14, s[28:31], s75 offen sc1
  s_waitcnt vmcnt(0)
  v_cmp_eq_u32 vcc, -1, v6
  s_cbranch_vccnz L_goslow
  s_branch L_oproj
L_guestdone:
  s_mov_b32 s79, 13
  s_mov_b32 s64, 0
  s_add_u32 s67, s67, 24576
  v_mov_b32 v64, 0
  v_mov_b32 v65, 0
  v_mov_b32 v66, 0
  v_mov_b32 v67, 0
  v_mov_b32 v68, 0
  v_mov_b32 v69, 0
  v_mov_b32 v70, 0
  v_mov_b32 v71, 0
  v_mov_b32 v72, 0
  v_mov_b32 v73, 0
  v_mov_b32 v74, 0
  v_mov_b32 v75, 0
  v_mov_b32 v76, 0
  v_mov_b32 v77, 0
  v_mov_b32 v78, 0
  v_mov_b32 v79, 0
  v_mov_b32 v80, 0
  v_mov_b32 v81, 0
  v_mov_b32 v82, 0
  v_mov_b32 v83, 0
  v_and_b32_dpp v20, v51, v8 row_newbcast:13 row_mask:0xf bank_mask:0xf
  v_and_b32_dpp v21, v51, v9 row_newbcast:13 row_mask:0xf bank_mask:0xf
  v_and_b32_dpp v22, v51, v10 row_newbcast:13 row_mask:0xf bank_mask:0xf
  v_and_b32_dpp v23, v51, v11 row_newbcast:13 row_mask:0xf bank_mask:0xf
  s_waitcnt vmcnt(12)
  s_nop 0
  v_mfma_f32_16x16x32_bf16 v[24:27], a[172:175], v[20:23], v[24:27]
  v_and_b32_dpp v16, v51, v8 row_newbcast:2 row_mask:0xf bank_mask:0xf
  v_and_b32_dpp v17, v51, v9 row_newbcast:2 row_mask:0xf bank_mask:0xf
  v_and_b32_dpp v18, v51, v10 row_newbcast:2 row_mask:0xf bank_mask:0xf
  v_and_b32_dpp v19, v51, v11 row_newbcast:2 row_mask:0xf bank_mask:0xf
  s_waitcnt vmcnt(11)
  s_nop 0
  v_mfma_f32_16x16x32_bf16 v[24:27], a[176:179], v[16:19], v[24:27]
  v_and_b32_dpp v20, v51, v8 row_newbcast:6 row_mask:0xf bank_mask:0xf
  v_and_b32_dpp v21, v51, v9 row_newbcast:6 row_mask:0xf bank_mask:0xf
  v_and_b32_dpp v22, v51, v10 row_newbcast:6 row_mask:0xf bank_mask:0xf
  v_and_b32_dpp v23, v51, v11 row_newbcast:6 row_mask:0xf bank_mask:0xf
  s_waitcnt vmcnt(10)
  s_nop 0
  v_mfma_f32_16x16x32_bf16 v[24:27], a[180:183], v[20:23], v[24:27]
  v_and_b32_dpp v16, v51, v8 row_newbcast:10 row_mask:0xf bank_mask:0xf
  v_and_b32_dpp v17, v51, v9 row_newbcast:10 row_mask:0xf bank_mask:0xf
  v_and_b32_dpp v18, v51, v10 row_newbcast:10 row_mask:0xf bank_mask:0xf
  v_and_b32_dpp v19, v51, v11 row_newbcast:10 row_mask:0xf bank_mask:0xf
  s_waitcnt vmcnt(9)
  s_nop 0
  v_mfma_f32_16x16x32_bf16 v[24:27], a[184:187], v[16:19], v[24:27]
  v_and_b32_dpp v20, v51, v8 row_newbcast:14 row_mask:0xf bank_mask:0xf
  v_and_b32_dpp v21, v51, v9 row_newbcast:14 row_mask:0xf bank_mask:0xf
  v_and_b32_dpp v22, v51, v10 row_newbcast:14 row_mask:0xf bank_mask:0xf
  v_and_b32_dpp v23, v51, v11 row_newbcast:14 row_mask:0xf bank_mask:0xf
  s_waitcnt vmcnt(8)
  s_nop 0
  v_mfma_f32_16x16x32_bf16 v[24:27], a[188:191], v[20:23], v[24:27]
  s_bitcmp1_b32 13, s3
  s_cbranch_scc0 L_tkH
  s_atomic_add s76, s[62:63], s74 glc
L_tkH:
  v_and_b32_dpp v16, v51, v8 row_newbcast:3 row_mask:0xf bank_mask:0xf
  v_and_b32_dpp v17, v51, v9 row_newbcast:3 row_mask:0xf bank_mask:0xf
  v_and_b32_dpp v18, v51, v10 row_newbcast:3 row_mask:0xf bank_mask:0xf
  v_and_b32_dpp v19, v51, v11 row_newbcast:3 row_mask:0xf bank_mask:0xf
  s_waitcnt vmcnt(7)
  s_nop 0
  v_mfma_f32_16x16x32_bf16 v[24:27], a[192:195], v[16:19], v[24:27]
  v_and_b32_dpp v20, v51, v8 row_newbcast:7 row_mask:0xf bank_mask:0xf
  v_and_b32_dpp v21, v51, v9 row_newbcast:7 row_mask:0xf bank_mask:0xf
  v_and_b32_dpp v22, v51, v10 row_newbcast:7 row_mask:0xf bank_mask:0xf
  v_and_b32_dpp v23, v51, v11 row_newbcast:7 row_mask:0xf bank_mask:0xf
  s_waitcnt vmcnt(6)
  s_nop 0
  v_mfma_f32_16x16x32_bf16 v[24:27], a[196:199], v[20:23], v[24:27]
  v_and_b32_dpp v16, v51, v8 row_newbcast:11 row_mask:0xf bank_mask:0xf
  v_and_b32_dpp v17, v51, v9 row_newbcast:11 row_mask:0xf bank_mask:0xf
  v_and_b32_dpp v18, v51, v10 row_newbcast:11 row_mask:0xf bank_mask:0xf
  v_and_b32_dpp v19, v51, v11 row_newbcast:11 row_mask:0xf bank_mask:0xf
  s_waitcnt vmcnt(5)
  s_nop 0
  v_mfma_f32_16x16x32_bf16 v[24:27], a[200:203], v[16:19], v[24:27]
  v_and_b32_dpp v20, v51, v8 row_newbcast:15 row_mask:0xf bank_mask:0xf
  v_and_b32_dpp v21, v51, v9 row_newbcast:15 row_mask:0xf bank_mask:0xf
  v_and_b32_dpp v22, v51, v10 row_newbcast:15 row_mask:0xf bank_mask:0xf
  v_and_b32_dpp v23, v51, v11 row_newbcast:15 row_mask:0xf bank_mask:0xf
  s_waitcnt vmcnt(4)
  s_nop 0
  v_mfma_f32_16x16x32_bf16 v[24:27], a[204:207], v[20:23], v[24:27]
L_finH:
  s_nop 7
  ds_write_b128 v3, v[24:27] offset:2304
  ds_read_b32 v95, v84
  s_waitcnt lgkmcnt(1)
  s_barrier
  ds_read2st64_b32 v[16:17], v84 offset0:9 offset1:13
  ds_read2st64_b32 v[18:19], v84 offset0:17 offset1:21
  ds_read_b32 v95, v84
  s_waitcnt lgkmcnt(1)
  v_pk_add_f32 v[16:17], v[16:17], v[18:19]
  v_add_f32 v16, v16, v17
  v_cvt_pk_bf16_f32 v6, v16, v16
  s_branch L_oproj
L_roleD:
  v_bfe_u32 v52, v0, 3, 1
  v_lshlrev_b32 v6, 3, v52
  v_bfe_u32 v52, v0, 4, 1
  v_lshl_or_b32 v6, v52, 2, v6
  v_bfe_u32 v52, v0, 5, 1
  v_lshl_or_b32 v6, v52, 0, v6
  v_bfe_u32 v52, v0, 6, 1
  v_lshl_or_b32 v6, v52, 1, v6
  v_bfe_u32 v52, v0, 7, 1
  v_lshl_or_b32 v6, v52, 4, v6
  v_mul_u32_u24 v91, 1280, v6
  v_bfe_u32 v6, v0, 4, 1
  v_bfe_u32 v52, v0, 6, 1
  v_lshl_or_b32 v6, v52, 1, v6
  v_lshlrev_b32 v6, 1, v6
  v_and_b32 v52, 7, v0
  v_xor_b32 v6, v6, v52
  v_lshl_add_u32 v91, v6, 4, v91
  s_mov_b32 s32, s56
  s_mov_b32 s33, s57
  s_mov_b32 s34, 2211840
  s_mov_b32 s35, 0x20000
  s_mul_i32 s7, s73, 81920
  s_lshl_b32 s65, s77, 7
  s_add_u32 s7, s7, s65
  v_add_u32 v91, s7, v91
  s_lshl_b32 s78, s3, 10
  s_add_u32 m0, s78, 38656
  s_mov_b32 s65, 0
  buffer_load_dwordx4 v91, s[32:35], s65 offen nt lds
  s_add_u32 m0, s78, 42752
  s_mov_b32 s65, 40960
  buffer_load_dwordx4 v91, s[32:35], s65 offen nt lds
  s_add_u32 m0, s78, 46848
  s_mov_b32 s65, 81920
  buffer_load_dwordx4 v91, s[32:35], s65 offen nt lds
  s_add_u32 m0, s78, 50944
  s_mov_b32 s65, 122880
  buffer_load_dwordx4 v91, s[32:35], s65 offen nt lds
  s_add_u32 m0, s78, 55040
  s_mov_b32 s65, 163840
  buffer_load_dwordx4 v91, s[32:35], s65 offen nt lds
  s_add_u32 m0, s78, 59136
  s_mov_b32 s65, 204800
  buffer_load_dwordx4 v91, s[32:35], s65 offen nt lds
  s_cmp_eq_u32 s72, 4
  s_cbranch_scc0 L_Dw3
  s_add_u32 m0, s78, 63232
  s_mov_b32 s65, 245760
  buffer_load_dwordx4 v91, s[32:35], s65 offen nt lds
  s_add_u32 m0, s78, 67328
  s_mov_b32 s65, 286720
  buffer_load_dwordx4 v91, s[32:35], s65 offen nt lds
L_Dw3:
  v_bfe_u32 v7, v0, 4, 2
  v_bfe_u32 v6, v0, 2, 2
  v_lshl_add_u32 v6, v7, 3, v6
  v_lshlrev_b32 v4, 7, v6
  v_bfe_u32 v6, v0, 3, 2
  v_xor_b32 v6, s3, v6
  v_lshl_add_u32 v4, v6, 5, v4
  v_and_b32 v6, 3, v0
  v_lshl_add_u32 v4, v6, 3, v4
  v_add_u32 v4, 38656, v4
  s_cmp_lt_u32 s77, 8
  s_cselect_b64 s[46:47], -1, 0
  v_bfe_u32 v59, v0, 4, 1
  v_bfe_u32 v53, v0, 5, 1
  v_lshl_add_u32 v59, v59, 2, v53
  s_lshl_b32 s7, s3, 4
  s_lshl_b32 s44, s77, 6
  v_add_u32 v52, 0, v59
  v_and_b32 v55, 15, v0
  v_add_u32 v55, s7, v55
  v_mul_u32_u24 v54, 640, v52
  v_add_u32 v54, s44, v54
  v_add_lshl_u32 v84, v54, v55, 1
  buffer_load_ushort v92, v84, s[24:27], 0 offen
  v_and_b32 v56, 7, v55
  v_mul_u32_u24 v57, 86, v56
  v_lshrrev_b32 v57, 8, v57
  v_mul_u32_u24 v58, 29, v57
  v_add_u32 v56, v56, v58
  v_lshrrev_b32 v57, 3, v55
  v_lshl_add_u32 v56, v57, 2, v56
  v_lshrrev_b32 v57, 1, v55
  v_and_b32 v58, 1, v55
  v_lshl_add_u32 v57, v57, 2, v58
  v_cndmask_b32 v56, v57, v56, s[46:47]
  v_lshl_add_u32 v56, v52, 7, v56
  v_lshlrev_b32 v8, 2, v56
  v_add_u32 v52, 2, v59
  v_and_b32 v55, 15, v0
  v_add_u32 v55, s7, v55
  v_mul_u32_u24 v54, 640, v52
  v_add_u32 v54, s44, v54
  v_add_lshl_u32 v85, v54, v55, 1
  buffer_load_ushort v93, v85, s[24:27], 0 offen
  v_and_b32 v56, 7, v55
  v_mul_u32_u24 v57, 86, v56
  v_lshrrev_b32 v57, 8, v57
  v_mul_u32_u24 v58, 29, v57
  v_add_u32 v56, v56, v58
  v_lshrrev_b32 v57, 3, v55
  v_lshl_add_u32 v56, v57, 2, v56
  v_lshrrev_b32 v57, 1, v55
  v_and_b32 v58, 1, v55
  v_lshl_add_u32 v57, v57, 2, v58
  v_cndmask_b32 v56, v57, v56, s[46:47]
  v_lshl_add_u32 v56, v52, 7, v56
  v_lshlrev_b32 v9, 2, v56
  v_bfe_u32 v52, v0, 2, 1
  v_xor_b32 v52, 1, v52
  v_lshl_add_u32 v52, v52, 1, v59
  v_mov_b32 v55, 15
  v_add_u32 v55, s7, v55
  v_mul_u32_u24 v54, 640, v52
  v_add_u32 v54, s44, v54
  v_add_lshl_u32 v86, v54, v55, 1
  buffer_load_ushort v94, v86, s[24:27], 0 offen
  v_and_b32 v56, 7, v55
  v_mul_u32_u24 v57, 86, v56
  v_lshrrev_b32 v57, 8, v57
  v_mul_u32_u24 v58, 29, v57
  v_add_u32 v56, v56, v58
  v_lshrrev_b32 v57, 3, v55
  v_lshl_add_u32 v56, v57, 2, v56
  v_lshrrev_b32 v57, 1, v55
  v_and_b32 v58, 1, v55
  v_lshl_add_u32 v57, v57, 2, v58
  v_cndmask_b32 v56, v57, v56, s[46:47]
  v_lshl_add_u32 v56, v52, 7, v56
  v_lshlrev_b32 v10, 2, v56
  buffer_load_ushort v95, v84, s[36:39], 0 offen
  v_and_b32 v52, 7, v0
  v_bfe_u32 v55, v0, 3, 2
  v_lshl_add_u32 v55, v55, 6, v52
  s_lshl_b32 s7, s77, 3
  v_add_u32 v55, s7, v55
  v_and_b32 v56, 31, v0
  s_lshl_b32 s7, s77, 5
  s_sub_u32 s7, s7, 64
  v_add_u32 v56, s7, v56
  v_cndmask_b32 v55, v56, v55, s[46:47]
  v_lshrrev_b32 v56, 5, v0
  v_lshl_add_u32 v55, v56, 8, v55
  v_lshlrev_b32 v12, 4, v55
  s_mul_i32 s7, s77, 3072
  s_add_u32 s7, s7, 33792
  v_lshrrev_b32 v55, 4, v0
  v_mul_u32_u24 v55, 0, v55
  v_add3_u32 v13, s7, v89, v55
  s_add_u32 s73, s73, s3
  s_lshl_b32 s76, s73, 10
  s_add_u32 s76, s76, 106496
  s_add_u32 s74, s76, 27648
  s_mov_b32 s48, 0x7fff7fff
  s_mov_b32 s49, 0x7fff7fff
  s_mov_b32 s50, 0x7fff7fff
  s_mov_b32 s51, 0x7fff7fff
  s_mov_b32 s52, 0x11001100
  s_mov_b32 s53, 0x11001100
  s_mov_b32 s54, 0
  s_mov_b32 s55, -1
  s_mov_b32 s42, 0x00003f80
  s_mov_b32 s43, 0x3f800000
  v_bfe_u32 v52, v0, 4, 2
  v_bfe_u32 v53, v0, 1, 1
  v_lshl_or_b32 v52, v52, 1, v53
  v_bfe_u32 v53, v0, 2, 1
  v_lshl_or_b32 v52, v52, 1, v53
  v_and_b32 v53, 1, v0
  v_lshl_or_b32 v52, v52, 1, v53
  v_bfe_u32 v53, v0, 3, 1
  v_lshl_or_b32 v52, v52, 1, v53
  v_lshlrev_b32 v11, 4, v52
  v_mul_u32_u24 v62, 0xaaaa, v53
  v_add_u32 v62, 0x4444, v62
  v_mov_b32 v87, 0x40e00000
  v_mov_b32 v176, 1.0
  v_mov_b32 v180, 0
  v_mov_b32 v177, 1.0
  v_mov_b32 v181, 0
  v_mov_b32 v178, 1.0
  v_mov_b32 v182, 0
  s_mov_b32 s66, 1
  s_branch L_Dbody
L_Dprep:
  s_mov_b32 s66, 0
  s_waitcnt vmcnt(0)
L_Dbar:
  s_barrier
  ds_read_b64_tr_b16 v[128:129], v4 offset:0
  ds_read_b64_tr_b16 v[130:131], v4 offset:512
  ds_read_b64_tr_b16 v[132:133], v4 offset:4096
  ds_read_b64_tr_b16 v[134:135], v4 offset:4608
  ds_read_b64_tr_b16 v[136:137], v4 offset:8192
  ds_read_b64_tr_b16 v[138:139], v4 offset:8704
  ds_read_b64_tr_b16 v[140:141], v4 offset:12288
  ds_read_b64_tr_b16 v[142:143], v4 offset:12800
  ds_read_b64_tr_b16 v[144:145], v4 offset:16384
  ds_read_b64_tr_b16 v[146:147], v4 offset:16896
  ds_read_b64_tr_b16 v[148:149], v4 offset:20480
  ds_read_b64_tr_b16 v[150:151], v4 offset:20992
  s_waitcnt lgkmcnt(4)
  ds_read_b64_tr_b16 v[152:153], v4 offset:24576
  ds_read_b64_tr_b16 v[154:155], v4 offset:25088
  ds_read_b64_tr_b16 v[156:157], v4 offset:28672
  ds_read_b64_tr_b16 v[158:159], v4 offset:29184
  v_mov_b32 v64, 0
  v_mov_b32 v65, 0
  v_mov_b32 v66, 0
  v_mov_b32 v67, 0
  v_mov_b32 v68, 0
  v_mov_b32 v69, 0
  v_mov_b32 v70, 0
  v_mov_b32 v71, 0
  s_waitcnt lgkmcnt(0)
  s_cmp_eq_u32 s72, 4
  s_cbranch_scc1 L_Dh1
  v_mov_b32 v152, 0
  v_mov_b32 v153, 0
  v_mov_b32 v154, 0
  v_mov_b32 v155, 0
  v_mov_b32 v156, 0
  v_mov_b32 v157, 0
  v_mov_b32 v158, 0
  v_mov_b32 v159, 0
L_Dh1:
  v_lshlrev_b32 v92, 16, v92
  v_lshlrev_b32 v93, 16, v93
  v_lshlrev_b32 v94, 16, v94
  s_cmp_lt_u32 s3, s72
  s_cbranch_scc0 L_Dbody
L_Dpoll2:
  buffer_load_dwordx4 v[64:67], v90, s[28:31], s76 offen sc1
  buffer_load_dwordx4 v[68:71], v90, s[28:31], s74 offen sc1
  s_add_u32 s100, s100, 1
  s_cmp_gt_u32 s100, 200000
  s_cbranch_scc1 L_end
  s_waitcnt vmcnt(1)
  v_max3_u32 v6, v64, v65, v66
  s_waitcnt vmcnt(0)
  v_max3_u32 v7, v67, v68, v69
  v_max3_u32 v6, v6, v70, v71
  v_max_u32 v6, v6, v7
  v_cmp_eq_u32 vcc, -1, v6
  s_cbranch_vccnz L_Dpoll2
L_Dbody:
  v_and_b32 v52, 0xffff, v64
  v_and_b32 v53, 0xffff0000, v64
  v_dot2_f32_bf16 v32, v52, v68, 0
  v_dot2_f32_bf16 v33, v53, v68, 0
  v_and_b32 v52, 0xffff, v65
  v_and_b32 v53, 0xffff0000, v65
  v_dot2_f32_bf16 v34, v52, v69, 0
  v_dot2_f32_bf16 v35, v53, v69, 0
  v_and_b32 v52, 0xffff, v66
  v_and_b32 v53, 0xffff0000, v66
  v_dot2_f32_bf16 v36, v52, v70, 0
  v_dot2_f32_bf16 v37, v53, v70, 0
  v_and_b32 v52, 0xffff, v67
  v_and_b32 v53, 0xffff0000, v67
  v_dot2_f32_bf16 v38, v52, v71, 0
  v_dot2_f32_bf16 v39, v53, v71, 0
  v_cvt_pk_bf16_f32 v72, v32, v33
  v_cvt_pk_bf16_f32 v73, v34, v35
  v_cvt_pk_bf16_f32 v74, v36, v37
  v_cvt_pk_bf16_f32 v75, v38, v39
  ds_write_b128 v3, v[72:75] offset:2304
  v_mov_b32 v24, 0
  v_mov_b32 v25, 0
  v_mov_b32 v26, 0
  v_mov_b32 v27, 0
  s_waitcnt lgkmcnt(0)
  s_barrier
  ds_read_b128 v[192:195], v11 offset:2304
  ds_read_b128 v[196:199], v11 offset:3328
  ds_read_b128 v[200:203], v11 offset:4352
  ds_read_b128 v[204:207], v11 offset:5376
  s_cmp_eq_u32 s66, 0
  s_cbranch_scc0 L_Dnl
  buffer_load_dwordx4 v[184:187], v12, s[28:31], 0 offen sc1
L_Dnl:
  s_waitcnt lgkmcnt(3)
  v_smfmac_f32_16x16x64_bf16 v[24:27], v[192:195], v[128:135], v62
  s_waitcnt lgkmcnt(2)
  v_smfmac_f32_16x16x64_bf16 v[24:27], v[196:199], v[136:143], v62
  s_waitcnt lgkmcnt(1)
  v_smfmac_f32_16x16x64_bf16 v[24:27], v[200:203], v[144:151], v62
  s_waitcnt lgkmcnt(0)
  v_smfmac_f32_16x16x64_bf16 v[24:27], v[204:207], v[152:159], v62
  s_nop 7
  v_permlane32_swap_b32 v24, v25
  v_permlane32_swap_b32 v26, v27
  v_add_f32 v28, v24, v25
  v_add_f32 v29, v26, v27
  v_cndmask_b32 v176, 1.0, v28, s[48:49]
  s_cbranch_scc0 L_Dna0
  global_atomic_add_f32 v180, v13, v176, s[62:63] offset:-1024 sc0
L_Dna0:
  v_cndmask_b32 v177, 1.0, v29, s[48:49]
  v_mov_b32_dpp v178, v28 row_newbcast:15 row_mask:0xf bank_mask:0x8
  v_mov_b32_dpp v178, v29 row_newbcast:15 row_mask:0xf bank_mask:0x4
  s_cbranch_scc0 L_Dna
  global_atomic_add_f32 v181, v13, v177, s[62:63] sc0
  global_atomic_add_f32 v182, v13, v178, s[62:63] offset:1024 sc0
  s_waitcnt vmcnt(3)
L_Dhc:
  v_cmp_neq_f32 vcc, 0x42000000, v187
  s_cbranch_vccnz L_Dhslow
L_Dna:
  ds_write_b128 v3, v[184:187] offset:27904
  s_waitcnt lgkmcnt(0)
  s_barrier
  ds_read_b32 v188, v8 offset:27904
  ds_read_b32 v189, v9 offset:27904
  ds_read_b32 v190, v10 offset:27904
  s_waitcnt lgkmcnt(0)
  v_cvt_pk_bf16_f32 v188, 0, v188
  v_add_f32 v188, v92, v188
  v_cvt_pk_bf16_f32 v188, 0, v188
  v_cvt_pk_bf16_f32 v189, 0, v189
  v_add_f32 v189, v93, v189
  v_cvt_pk_bf16_f32 v189, 0, v189
  v_cvt_pk_bf16_f32 v190, 0, v190
  v_add_f32 v190, v94, v190
  v_cvt_pk_bf16_f32 v190, 0, v190
  s_cmp_eq_u32 s66, 0
  s_cbranch_scc0 L_Dnv
  s_waitcnt vmcnt(0)
L_Dnv:
  v_pk_add_f32 v[184:185], v[176:177], v[180:181]
  v_add_f32 v186, v178, v182
  v_cvt_pk_bf16_f32 v184, 0, v184
  v_cvt_pk_bf16_f32 v185, 0, v185
  v_cvt_pk_bf16_f32 v186, 0, v186
  v_pk_add_f32 v[184:185], v[184:185], v[188:189]
  v_add_f32 v186, v186, v190
  v_mov_b32_dpp v52, v180 row_newbcast:15 row_mask:0xf bank_mask:0xf
  v_mov_b32_dpp v53, v181 row_newbcast:15 row_mask:0xf bank_mask:0xf
  v_cmp_eq_f32 vcc, v52, v87
  v_cvt_pk_bf16_f32 v6, v184, v185
  v_mov_b32_dpp v54, v182 row_newbcast:0 row_mask:0xf bank_mask:0xf
  v_cmp_eq_f32 s[40:41], v53, v87
  v_cvt_pk_bf16_f32 v7, v186, v186
  v_cmp_eq_f32 s[44:45], v54, v87
  s_and_b64 exec, vcc, s[48:49]
  s_cbranch_execz L_Dns0
  buffer_store_short v6, v84, s[36:39], 0 offen
L_Dns0:
  s_and_b64 exec, s[40:41], s[48:49]
  s_cbranch_execz L_Dns1
  buffer_store_short_d16_hi v6, v85, s[36:39], 0 offen
L_Dns1:
  s_and_b64 exec, s[44:45], s[52:53]
  s_cbranch_execz L_Dns2
  buffer_store_short v7, v86, s[36:39], 0 offen
L_Dns2:
  s_mov_b64 exec, -1
  s_cmp_eq_u32 s66, 0
  s_cbranch_scc0 L_Dprep
  s_endpgm
L_streamG:
  s_add_u32 s7, s2, 40
  s_sub_u32 s64, s2, 8
  s_cmp_lt_u32 s2, 8
  s_cselect_b32 s7, s7, s64
  s_mov_b32 s76, 32768
  s_cselect_b32 s76, s76, 0x7000000
  s_lshl_b32 s7, s7, 12
  s_cmp_lt_u32 s2, 48
  s_cselect_b32 s7, s7, 0x7000000
  s_sub_u32 s64, s2, 24
  s_cmp_lt_u32 s64, 7
  s_cselect_b32 s7, 0x7000000, s7
  s_cmp_lt_u32 s2, 34
  s_cselect_b32 s64, 0, -1
  v_mov_b32 v64, s64
  v_mov_b32 v65, s64
  v_mov_b32 v66, s64
  v_mov_b32 v67, s64
  v_mov_b32 v68, -1
  v_mov_b32 v69, -1
  v_mov_b32 v70, -1
  v_mov_b32 v71, -1
  v_add_u32 v72, s7, v3
  v_add_u32 v73, s76, v72
  buffer_store_dwordx4 v[64:67], v72, s[28:31], 0 offen sc1
  buffer_store_dwordx4 v[68:71], v73, s[28:31], 0 offen sc1
  v_bfe_u32 v53, v0, 3, 1
  s_lshl_b32 s7, s3, 1
  v_add_u32 v53, s7, v53
  v_lshlrev_b32 v53, 17, v53
  v_and_b32 v54, 7, v0
  v_lshl_add_u32 v54, v7, 3, v54
  v_lshl_add_u32 v74, v54, 4, v53
  s_lshl_b32 s7, s4, 12
  s_lshl_b32 s67, s5, 9
  s_add_u32 s67, s67, s7
  s_add_u32 s67, s67, 229376
  s_waitcnt vmcnt(9)
  s_waitcnt vmcnt(6)
  s_mov_b32 s65, 6144
  buffer_load_dwordx4 a[24:27], v2, s[8:11], s65 offen nt
  s_waitcnt vmcnt(6)
  s_mov_b32 s65, 98304
  buffer_load_dwordx4 v[200:203], v4, s[16:19], s65 offen nt
  s_min_u32 s7, s70, 3
  s_mul_i32 s73, s70, 3
  s_add_u32 s73, s73, s7
  s_lshr_b32 s7, s71, 1
  s_add_u32 s73, s73, s7
  s_and_b32 s7, s71, 1
  s_cselect_b32 s20, s54, s52
  s_cselect_b32 s21, s55, s53
  s_mov_b32 s22, 2211840
  s_mul_i32 s101, s7, 27
  s_add_u32 s101, s101, s73
  v_bfe_u32 v52, v0, 3, 1
  v_lshlrev_b32 v6, 0, v52
  v_bfe_u32 v52, v0, 4, 1
  v_lshl_or_b32 v6, v52, 3, v6
  v_bfe_u32 v52, v0, 5, 1
  v_lshl_or_b32 v6, v52, 1, v6
  v_bfe_u32 v52, v0, 6, 1
  v_lshl_or_b32 v6, v52, 2, v6
  v_bfe_u32 v52, v0, 7, 1
  v_lshl_or_b32 v6, v52, 4, v6
  v_mul_u32_u24 v91, 3456, v6
  v_bfe_u32 v6, v0, 4, 1
  v_bfe_u32 v52, v0, 6, 1
  v_lshl_or_b32 v6, v52, 1, v6
  v_lshlrev_b32 v6, 1, v6
  v_and_b32 v52, 7, v0
  v_xor_b32 v6, v6, v52
  v_lshl_add_u32 v91, v6, 4, v91
  s_lshl_b32 s7, s73, 7
  v_add_u32 v91, s7, v91
  s_lshl_b32 s7, s3, 10
  s_add_u32 s40, s7, 38656
  s_add_u32 s41, s7, 42752
  s_add_u32 s42, s7, 46848
  s_add_u32 s43, s7, 50944
  s_add_u32 s44, s7, 55040
  s_add_u32 s45, s7, 59136
  s_add_u32 s46, s7, 63232
  s_add_u32 s47, s7, 67328
  s_add_u32 s48, s7, 71424
  s_add_u32 s49, s7, 75520
  s_add_u32 s50, s7, 79616
  s_add_u32 s51, s7, 83712
  s_add_u32 s52, s7, 87808
  s_add_u32 s53, s7, 91904
  s_add_u32 s54, s7, 96000
  s_add_u32 s55, s7, 100096
  s_add_u32 s56, s7, 104192
  s_add_u32 s57, s7, 108288
  s_add_u32 s58, s7, 112384
  s_add_u32 s59, s7, 116480
  s_waitcnt vmcnt(6)
  s_mov_b32 s65, 7168
  buffer_load_dwordx4 a[28:31], v2, s[8:11], s65 offen nt
  s_waitcnt vmcnt(6)
  s_mov_b32 s65, 131072
  buffer_load_dwordx4 v[204:207], v4, s[16:19], s65 offen nt
  v_lshlrev_b32 v208, 16, v176
  v_and_b32 v209, 0xffff0000, v176
  v_lshlrev_b32 v210, 16, v177
  v_and_b32 v211, 0xffff0000, v177
  v_pk_add_f32 v[52:53], v[208:209], v[210:211]
  v_lshlrev_b32 v212, 16, v178
  v_and_b32 v213, 0xffff0000, v178
  v_pk_add_f32 v[52:53], v[52:53], v[212:213]
  v_lshlrev_b32 v214, 16, v179
  v_and_b32 v215, 0xffff0000, v179
  v_pk_add_f32 v[52:53], v[52:53], v[214:215]
  v_lshlrev_b32 v216, 16, v180
  v_and_b32 v217, 0xffff0000, v180
  v_pk_add_f32 v[52:53], v[52:53], v[216:217]
  v_lshlrev_b32 v218, 16, v181
  v_and_b32 v219, 0xffff0000, v181
  v_pk_add_f32 v[52:53], v[52:53], v[218:219]
  v_lshlrev_b32 v220, 16, v182
  v_and_b32 v221, 0xffff0000, v182
  v_pk_add_f32 v[52:53], v[52:53], v[220:221]
  v_lshlrev_b32 v222, 16, v183
  v_and_b32 v223, 0xffff0000, v183
  v_pk_add_f32 v[52:53], v[52:53], v[222:223]
  v_lshlrev_b32 v224, 16, v184
  v_and_b32 v225, 0xffff0000, v184
  v_pk_add_f32 v[52:53], v[52:53], v[224:225]
  v_lshlrev_b32 v226, 16, v185
  v_and_b32 v227, 0xffff0000, v185
  v_pk_add_f32 v[52:53], v[52:53], v[226:227]
  v_add_f32 v52, v52, v53
  s_nop 1
  v_add_f32_dpp v52, v52, v52 quad_perm:[1,0,3,2] row_mask:0xf bank_mask:0xf
  s_nop 1
  v_add_f32_dpp v52, v52, v52 quad_perm:[2,3,0,1] row_mask:0xf bank_mask:0xf
  s_nop 1
  v_add_f32_dpp v52, v52, v52 row_half_mirror row_mask:0xf bank_mask:0xf
  s_nop 1
  v_add_f32_dpp v52, v52, v52 row_mirror row_mask:0xf bank_mask:0xf
  v_mov_b32 v53, v52
  s_nop 1
  s_waitcnt vmcnt(6)
  s_mov_b32 s65, 32768
  buffer_load_dwordx4 a[32:35], v2, s[8:11], s65 offen nt
  v_permlane16_swap_b32 v52, v53
  s_nop 0
  v_add_f32 v52, v52, v53
  v_mul_f32 v52, 0xbacccccd, v52
  v_cvt_pk_bf16_f32 v54, 0, v52
  v_pk_add_f32 v[56:57], v[208:209], v[52:53] op_sel_hi:[1,0]
  v_pk_mul_f32 v[58:59], v[56:57], v[56:57]
  v_pk_add_f32 v[56:57], v[210:211], v[52:53] op_sel_hi:[1,0]
  v_pk_fma_f32 v[58:59], v[56:57], v[56:57], v[58:59]
  v_pk_add_f32 v[56:57], v[212:213], v[52:53] op_sel_hi:[1,0]
  v_pk_fma_f32 v[58:59], v[56:57], v[56:57], v[58:59]
  v_pk_add_f32 v[56:57], v[214:215], v[52:53] op_sel_hi:[1,0]
  v_pk_fma_f32 v[58:59], v[56:57], v[56:57], v[58:59]
  v_pk_add_f32 v[56:57], v[216:217], v[52:53] op_sel_hi:[1,0]
  v_pk_fma_f32 v[58:59], v[56:57], v[56:57], v[58:59]
  v_pk_add_f32 v[56:57], v[218:219], v[52:53] op_sel_hi:[1,0]
  v_pk_fma_f32 v[58:59], v[56:57], v[56:57], v[58:59]
  v_pk_add_f32 v[56:57], v[220:221], v[52:53] op_sel_hi:[1,0]
  v_pk_fma_f32 v[58:59], v[56:57], v[56:57], v[58:59]
  v_pk_add_f32 v[56:57], v[222:223], v[52:53] op_sel_hi:[1,0]
  v_pk_fma_f32 v[58:59], v[56:57], v[56:57], v[58:59]
  v_pk_add_f32 v[56:57], v[224:225], v[52:53] op_sel_hi:[1,0]
  v_pk_fma_f32 v[58:59], v[56:57], v[56:57], v[58:59]
  v_pk_add_f32 v[56:57], v[226:227], v[52:53] op_sel_hi:[1,0]
  v_pk_fma_f32 v[58:59], v[56:57], v[56:57], v[58:59]
  v_add_f32 v58, v58, v59
  v_pk_add_f32 v[208:209], v[208:209], v[54:55] op_sel_hi:[1,0]
  v_cvt_pk_bf16_f32 v6, v208, v209
  v_lshlrev_b32 v208, 16, v6
  v_and_b32 v209, 0xffff0000, v6
  v_add_f32_dpp v58, v58, v58 quad_perm:[1,0,3,2] row_mask:0xf bank_mask:0xf
  v_pk_add_f32 v[210:211], v[210:211], v[54:55] op_sel_hi:[1,0]
  v_cvt_pk_bf16_f32 v6, v210, v211
  v_lshlrev_b32 v210, 16, v6
  v_and_b32 v211, 0xffff0000, v6
  v_add_f32_dpp v58, v58, v58 quad_perm:[2,3,0,1] row_mask:0xf bank_mask:0xf
  v_pk_add_f32 v[212:213], v[212:213], v[54:55] op_sel_hi:[1,0]
  v_cvt_pk_bf16_f32 v6, v212, v213
  v_lshlrev_b32 v212, 16, v6
  v_and_b32 v213, 0xffff0000, v6
  v_add_f32_dpp v58, v58, v58 row_half_mirror row_mask:0xf bank_mask:0xf
  v_pk_add_f32 v[214:215], v[214:215], v[54:55] op_sel_hi:[1,0]
  v_cvt_pk_bf16_f32 v6, v214, v215
  v_lshlrev_b32 v214, 16, v6
  v_and_b32 v215, 0xffff0000, v6
  v_add_f32_dpp v58, v58, v58 row_mirror row_mask:0xf bank_mask:0xf
  v_mov_b32 v59, v58
  s_mul_i32 s65, s5, 5120
  buffer_load_dwordx4 v[172:175], v5, s[32:35], s65 offen offset:0
  v_pk_add_f32 v[216:217], v[216:217], v[54:55] op_sel_hi:[1,0]
  v_cvt_pk_bf16_f32 v6, v216, v217
  v_lshlrev_b32 v216, 16, v6
  v_and_b32 v217, 0xffff0000, v6
  v_permlane16_swap_b32 v58, v59
  v_pk_add_f32 v[218:219], v[218:219], v[54:55] op_sel_hi:[1,0]
  v_cvt_pk_bf16_f32 v6, v218, v219
  v_lshlrev_b32 v218, 16, v6
  v_and_b32 v219, 0xffff0000, v6
  v_add_f32 v58, v58, v59
  v_mul_f32 v58, 0x3acccccd, v58
  v_cvt_pk_bf16_f32 v58, 0, v58
  v_add_f32 v58, 0x3727c5ac, v58
  v_cvt_pk_bf16_f32 v58, 0, v58
  v_sqrt_f32 v58, v58
  v_pk_add_f32 v[220:221], v[220:221], v[54:55] op_sel_hi:[1,0]
  v_cvt_pk_bf16_f32 v6, v220, v221
  v_lshlrev_b32 v220, 16, v6
  v_and_b32 v221, 0xffff0000, v6
  v_cvt_pk_bf16_f32 v58, 0, v58
  v_rcp_f32 v58, v58
  v_pk_add_f32 v[222:223], v[222:223], v[54:55] op_sel_hi:[1,0]
  v_cvt_pk_bf16_f32 v6, v222, v223
  v_lshlrev_b32 v222, 16, v6
  v_and_b32 v223, 0xffff0000, v6
  v_pk_add_f32 v[224:225], v[224:225], v[54:55] op_sel_hi:[1,0]
  v_cvt_pk_bf16_f32 v6, v224, v225
  v_lshlrev_b32 v224, 16, v6
  v_and_b32 v225, 0xffff0000, v6
  v_pk_add_f32 v[226:227], v[226:227], v[54:55] op_sel_hi:[1,0]
  v_cvt_pk_bf16_f32 v6, v226, v227
  v_lshlrev_b32 v226, 16, v6
  v_and_b32 v227, 0xffff0000, v6
  v_pk_mul_f32 v[208:209], v[208:209], v[58:59] op_sel_hi:[1,0]
  v_cvt_pk_bf16_f32 v176, v208, v209
  v_pk_mul_f32 v[210:211], v[210:211], v[58:59] op_sel_hi:[1,0]
  v_cvt_pk_bf16_f32 v177, v210, v211
  v_pk_mul_f32 v[212:213], v[212:213], v[58:59] op_sel_hi:[1,0]
  v_cvt_pk_bf16_f32 v178, v212, v213
  v_pk_mul_f32 v[214:215], v[214:215], v[58:59] op_sel_hi:[1,0]
  v_cvt_pk_bf16_f32 v179, v214, v215
  ds_write_b128 v13, v[176:179] offset:27904
  s_mul_i32 s65, s5, 5120
  buffer_load_dwordx4 v[172:175], v5, s[32:35], s65 offen offset:256
  v_pk_mul_f32 v[216:217], v[216:217], v[58:59] op_sel_hi:[1,0]
  v_cvt_pk_bf16_f32 v180, v216, v217
  v_pk_mul_f32 v[218:219], v[218:219], v[58:59] op_sel_hi:[1,0]
  v_cvt_pk_bf16_f32 v181, v218, v219
  v_pk_mul_f32 v[220:221], v[220:221], v[58:59] op_sel_hi:[1,0]
  v_cvt_pk_bf16_f32 v182, v220, v221
  v_pk_mul_f32 v[222:223], v[222:223], v[58:59] op_sel_hi:[1,0]
  v_cvt_pk_bf16_f32 v183, v222, v223
  ds_write_b128 v13, v[180:183] offset:28416
  v_pk_mul_f32 v[224:225], v[224:225], v[58:59] op_sel_hi:[1,0]
  v_cvt_pk_bf16_f32 v184, v224, v225
  v_pk_mul_f32 v[226:227], v[226:227], v[58:59] op_sel_hi:[1,0]
  v_cvt_pk_bf16_f32 v185, v226, v227
  ds_write_b64 v94, v[184:185] offset:28928
  s_mul_i32 s65, s5, 5120
  buffer_load_dwordx4 v[172:175], v5, s[32:35], s65 offen offset:512
  s_waitcnt lgkmcnt(0)
  s_barrier
  ds_read_u16 v208, v14 offset:27904
  ds_read_u16 v209, v14 offset:30592
  ds_read_u16 v210, v14 offset:33280
  ds_read_u16 v211, v14 offset:35968
  ds_read_u16 v212, v14 offset:27912
  ds_read_u16 v213, v14 offset:30600
  ds_read_u16 v214, v14 offset:33288
  ds_read_u16 v215, v14 offset:35976
  ds_read_u16 v216, v14 offset:27920
  ds_read_u16 v217, v14 offset:30608
  ds_read_u16 v218, v14 offset:33296
  ds_read_u16 v219, v14 offset:35984
  s_waitcnt lgkmcnt(0)
  ds_read_u16 v220, v14 offset:27928
  ds_read_u16 v221, v14 offset:30616
  ds_read_u16 v222, v14 offset:33304
  ds_read_u16 v223, v14 offset:35992
  ds_read_u16 v224, v14 offset:27936
  ds_read_u16 v225, v14 offset:30624
  ds_read_u16 v226, v14 offset:33312
  ds_read_u16 v227, v14 offset:36000
  s_waitcnt lgkmcnt(0)
  s_mul_i32 s65, s5, 5120
  buffer_load_dwordx4 v[172:175], v5, s[32:35], s65 offen offset:768
  v_lshl_or_b32 v208, v208, 16, v208
  v_and_b32 v16, v208, v8
  v_and_b32 v17, v208, v9
  v_and_b32 v18, v208, v10
  v_and_b32 v19, v208, v11
  s_nop 1
  v_mfma_f32_16x16x32_bf16 v[228:231], v[188:191], v[16:19], 0
  v_lshl_or_b32 v209, v209, 16, v209
  v_and_b32 v20, v209, v8
  v_and_b32 v21, v209, v9
  v_and_b32 v22, v209, v10
  v_and_b32 v23, v209, v11
  s_nop 1
  v_mfma_f32_16x16x32_bf16 v[232:235], v[188:191], v[20:23], 0
  v_lshl_or_b32 v210, v210, 16, v210
  v_and_b32 v16, v210, v8
  v_and_b32 v17, v210, v9
  v_and_b32 v18, v210, v10
  v_and_b32 v19, v210, v11
  s_nop 1
  v_mfma_f32_16x16x32_bf16 v[236:239], v[188:191], v[16:19], 0
  v_lshl_or_b32 v211, v211, 16, v211
  v_and_b32 v20, v211, v8
  v_and_b32 v21, v211, v9
  v_and_b32 v22, v211, v10
  v_and_b32 v23, v211, v11
  s_nop 1
  v_mfma_f32_16x16x32_bf16 v[240:243], v[188:191], v[20:23], 0
  v_lshl_or_b32 v212, v212, 16, v212
  v_and_b32 v16, v212, v8
  v_and_b32 v17, v212, v9
  v_and_b32 v18, v212, v10
  v_and_b32 v19, v212, v11
  s_nop 1
  v_mfma_f32_16x16x32_bf16 v[228:231], v[192:195], v[16:19], v[228:231]
  s_mul_i32 s65, s5, 5120
  buffer_load_dwordx4 v[172:175], v5, s[32:35], s65 offen offset:1024
  v_lshl_or_b32 v213, v213, 16, v213
  v_and_b32 v20, v213, v8
  v_and_b32 v21, v213, v9
  v_and_b32 v22, v213, v10
  v_and_b32 v23, v213, v11
  s_nop 1
  v_mfma_f32_16x16x32_bf16 v[232:235], v[192:195], v[20:23], v[232:235]
  v_lshl_or_b32 v214, v214, 16, v214
  v_and_b32 v16, v214, v8
  v_and_b32 v17, v214, v9
  v_and_b32 v18, v214, v10
  v_and_b32 v19, v214, v11
  s_nop 1
  v_mfma_f32_16x16x32_bf16 v[236:239], v[192:195], v[16:19], v[236:239]
  v_lshl_or_b32 v215, v215, 16, v215
  v_and_b32 v20, v215, v8
  v_and_b32 v21, v215, v9
  v_and_b32 v22, v215, v10
  v_and_b32 v23, v215, v11
  s_nop 1
  v_mfma_f32_16x16x32_bf16 v[240:243], v[192:195], v[20:23], v[240:243]
  v_lshl_or_b32 v216, v216, 16, v216
  v_and_b32 v16, v216, v8
  v_and_b32 v17, v216, v9
  v_and_b32 v18, v216, v10
  v_and_b32 v19, v216, v11
  s_nop 1
  v_mfma_f32_16x16x32_bf16 v[228:231], v[196:199], v[16:19], v[228:231]
  v_lshl_or_b32 v217, v217, 16, v217
  v_and_b32 v20, v217, v8
  v_and_b32 v21, v217, v9
  v_and_b32 v22, v217, v10
  v_and_b32 v23, v217, v11
  s_nop 1
  v_mfma_f32_16x16x32_bf16 v[232:235], v[196:199], v[20:23], v[232:235]
  s_mov_b32 s65, 33792
  buffer_load_dwordx4 a[36:39], v2, s[8:11], s65 offen nt
  v_lshl_or_b32 v218, v218, 16, v218
  v_and_b32 v16, v218, v8
  v_and_b32 v17, v218, v9
  v_and_b32 v18, v218, v10
  v_and_b32 v19, v218, v11
  s_nop 1
  v_mfma_f32_16x16x32_bf16 v[236:239], v[196:199], v[16:19], v[236:239]
  v_lshl_or_b32 v219, v219, 16, v219
  v_and_b32 v20, v219, v8
  v_and_b32 v21, v219, v9
  v_and_b32 v22, v219, v10
  v_and_b32 v23, v219, v11
  s_nop 1
  v_mfma_f32_16x16x32_bf16 v[240:243], v[196:199], v[20:23], v[240:243]
  s_waitcnt vmcnt(9)
  v_lshl_or_b32 v220, v220, 16, v220
  v_and_b32 v16, v220, v8
  v_and_b32 v17, v220, v9
  v_and_b32 v18, v220, v10
  v_and_b32 v19, v220, v11
  s_nop 1
  v_mfma_f32_16x16x32_bf16 v[228:231], v[200:203], v[16:19], v[228:231]
  v_lshl_or_b32 v221, v221, 16, v221
  v_and_b32 v20, v221, v8
  v_and_b32 v21, v221, v9
  v_and_b32 v22, v221, v10
  v_and_b32 v23, v221, v11
  s_nop 1
  v_mfma_f32_16x16x32_bf16 v[232:235], v[200:203], v[20:23], v[232:235]
  v_lshl_or_b32 v222, v222, 16, v222
  v_and_b32 v16, v222, v8
  v_and_b32 v17, v222, v9
  v_and_b32 v18, v222, v10
  v_and_b32 v19, v222, v11
  s_nop 1
  s_waitcnt vmcnt(6)
  s_mov_b32 s65, 34816
  buffer_load_dwordx4 a[40:43], v2, s[8:11], s65 offen nt
  v_mfma_f32_16x16x32_bf16 v[236:239], v[200:203], v[16:19], v[236:239]
  v_lshl_or_b32 v223, v223, 16, v223
  v_and_b32 v20, v223, v8
  v_and_b32 v21, v223, v9
  v_and_b32 v22, v223, v10
  v_and_b32 v23, v223, v11
  s_nop 1
  v_mfma_f32_16x16x32_bf16 v[240:243], v[200:203], v[20:23], v[240:243]
  v_lshl_or_b32 v224, v224, 16, v224
  v_and_b32 v16, v224, v8
  v_and_b32 v17, v224, v9
  v_and_b32 v18, v224, v10
  v_and_b32 v19, v224, v11
  s_nop 1
  v_mfma_f32_16x16x32_bf16 v[228:231], v[204:207], v[16:19], v[228:231]
  v_lshl_or_b32 v225, v225, 16, v225
  v_and_b32 v20, v225, v8
  v_and_b32 v21, v225, v9
  v_and_b32 v22, v225, v10
  v_and_b32 v23, v225, v11
  s_nop 1
  v_mfma_f32_16x16x32_bf16 v[232:235], v[204:207], v[20:23], v[232:235]
  v_lshl_or_b32 v226, v226, 16, v226
  v_and_b32 v16, v226, v8
  v_and_b32 v17, v226, v9
  v_and_b32 v18, v226, v10
  v_and_b32 v19, v226, v11
  s_nop 1
  v_mfma_f32_16x16x32_bf16 v[236:239], v[204:207], v[16:19], v[236:239]
  v_lshl_or_b32 v227, v227, 16, v227
  v_and_b32 v20, v227, v8
  v_and_b32 v21, v227, v9
  v_and_b32 v22, v227, v10
  s_waitcnt vmcnt(6)
  s_mov_b32 s65, 35840
  buffer_load_dwordx4 a[44:47], v2, s[8:11], s65 offen nt
  v_and_b32 v23, v227, v11
  s_nop 1
  v_mfma_f32_16x16x32_bf16 v[240:243], v[204:207], v[20:23], v[240:243]
  s_lshl_b32 s7, s3, 12
  v_add_u32 v52, s7, v90
  v_and_b32 v53, 0x7f0, v3
  v_lshrrev_b32 v54, 7, v0
  v_lshl_add_u32 v53, v54, 3, v53
  s_nop 2
  ds_write_b128 v52, v[228:231] offset:6400
  ds_write_b128 v52, v[232:235] offset:7424
  ds_write_b128 v52, v[236:239] offset:8448
  ds_write_b128 v52, v[240:243] offset:9472
  s_mov_b32 s65, 36864
  buffer_load_dwordx4 a[48:51], v2, s[8:11], s65 offen nt
  s_waitcnt lgkmcnt(0)
  s_barrier
  ds_read_b128 v[208:211], v3 offset:6400
  ds_read_b128 v[212:215], v3 offset:10496
  ds_read_b128 v[216:219], v3 offset:14592
  ds_read_b128 v[220:223], v3 offset:18688
  s_getreg_b32 s77, hwreg(HW_REG_XCC_ID, 0, 4)
  s_add_u32 s77, s77, 1
  s_and_b32 s78, s2, 7
  s_lshl_b32 s78, s78, 2
  s_waitcnt lgkmcnt(0)
  s_sub_u32 s76, s2, 8
  s_lshl_b32 s76, 1, s76
  s_cmp_lt_u32 s2, 8
  s_cselect_b32 s76, s77, s76
  s_cselect_b32 s7, s78, 128
  s_cmp_lt_u32 s2, 40
  s_cselect_b32 s7, s7, 132
  s_cmp_lt_u32 s2, 48
  s_cselect_b32 s64, s3, 1
  s_cmp_eq_u32 s64, 0
  s_cbranch_scc0 L_nosigG
  s_atomic_or s76, s[60:61], s7
L_nosigG:
  s_waitcnt vmcnt(6)
  s_mov_b32 s65, 37888
  buffer_load_dwordx4 a[52:55], v2, s[8:11], s65 offen nt
  v_pk_add_f32 v[208:209], v[208:209], v[212:213]
  v_pk_add_f32 v[216:217], v[216:217], v[220:221]
  v_pk_add_f32 v[208:209], v[208:209], v[216:217]
  v_pk_add_f32 v[210:211], v[210:211], v[214:215]
  v_pk_add_f32 v[218:219], v[218:219], v[222:223]
  v_pk_add_f32 v[210:211], v[210:211], v[218:219]
  buffer_store_dwordx4 v[208:211], v74, s[28:31], s67 offen
  s_waitcnt vmcnt(7)
  s_mov_b32 s65, 38912
  buffer_load_dwordx4 a[56:59], v2, s[8:11], s65 offen nt
  s_waitcnt vmcnt(7)
  s_mov_b32 s65, 39936
  buffer_load_dwordx4 a[60:63], v2, s[8:11], s65 offen nt
  s_waitcnt vmcnt(7)
  s_mov_b32 s65, 65536
  buffer_load_dwordx4 a[64:67], v2, s[8:11], s65 offen nt
  s_waitcnt vmcnt(7)
  s_mov_b32 s65, 66560
  buffer_load_dwordx4 a[68:71], v2, s[8:11], s65 offen nt
  s_waitcnt vmcnt(7)
  s_mov_b32 s65, 67584
  buffer_load_dwordx4 a[72:75], v2, s[8:11], s65 offen nt
  s_waitcnt vmcnt(7)
  s_mov_b32 s65, 68608
  buffer_load_dwordx4 a[76:79], v2, s[8:11], s65 offen nt
  s_waitcnt vmcnt(7)
  s_mov_b32 s65, 69632
  buffer_load_dwordx4 a[80:83], v2, s[8:11], s65 offen nt
  s_waitcnt vmcnt(7)
  s_mov_b32 s65, 70656
  buffer_load_dwordx4 a[84:87], v2, s[8:11], s65 offen nt
  s_waitcnt vmcnt(7)
  s_mov_b32 s65, 71680
  buffer_load_dwordx4 a[88:91], v2, s[8:11], s65 offen nt
  s_waitcnt vmcnt(7)
  s_mov_b32 s65, 72704
  buffer_load_dwordx4 a[92:95], v2, s[8:11], s65 offen nt
  s_waitcnt vmcnt(7)
  s_mov_b32 s65, 98304
  buffer_load_dwordx4 a[96:99], v2, s[8:11], s65 offen nt
  s_waitcnt vmcnt(7)
  s_mov_b32 s65, 99328
  buffer_load_dwordx4 a[100:103], v2, s[8:11], s65 offen nt
  s_waitcnt vmcnt(7)
  s_mov_b32 s65, 100352
  buffer_load_dwordx4 a[104:107], v2, s[8:11], s65 offen nt
  s_waitcnt vmcnt(7)
  s_mov_b32 s65, 101376
  buffer_load_dwordx4 a[108:111], v2, s[8:11], s65 offen nt
  s_waitcnt vmcnt(7)
  s_mov_b32 s65, 102400
  buffer_load_dwordx4 a[112:115], v2, s[8:11], s65 offen nt
  s_waitcnt vmcnt(7)
  s_mov_b32 s65, 103424
  buffer_load_dwordx4 a[116:119], v2, s[8:11], s65 offen nt
  s_waitcnt vmcnt(7)
  s_mov_b32 s65, 104448
  buffer_load_dwordx4 a[120:123], v2, s[8:11], s65 offen nt
  s_load_dword s79, s[60:61], s78
  s_waitcnt vmcnt(7)
  s_mov_b32 s65, 105472
  buffer_load_dwordx4 a[124:127], v2, s[8:11], s65 offen nt
  s_waitcnt vmcnt(7)
  s_mov_b32 s65, 131072
  buffer_load_dwordx4 a[128:131], v2, s[8:11], s65 offen nt
  s_waitcnt vmcnt(7)
  s_mov_b32 s65, 132096
  buffer_load_dwordx4 a[132:135], v2, s[8:11], s65 offen nt
  s_lshl_b32 s75, s78, 10
  s_add_u32 s75, s75, 163840
  s_lshr_b32 s7, s2, 3
  s_lshl_b32 s74, s7, 7
  s_add_u32 s74, s74, s75
  s_and_b32 s7, s7, 3
  s_lshl_b32 s7, s7, 7
  s_add_u32 s75, s75, s7
  v_mov_b32 v53, 1
  s_and_b32 s7, s5, 4
  s_add_u32 s7, s7, s3
  v_lshrrev_b32 v52, 5, v0
  v_lshlrev_b32 v52, 9, v52
  s_mov_b32 s64, 0
  s_waitcnt lgkmcnt(0)
  s_cmp_eq_u32 s79, s77
  s_cbranch_scc0 L_lslowG
L_lokG:
  s_barrier
  s_cmp_eq_u32 s3, 0
  s_cbranch_scc0 L_noqfG
  s_mov_b64 exec, 1
  buffer_store_dword v53, off, s[28:31], s74
  s_mov_b64 exec, -1
L_noqfG:
  s_waitcnt vmcnt(6)
  s_mov_b32 s65, 133120
  buffer_load_dwordx4 a[136:139], v2, s[8:11], s65 offen nt
  v_and_b32 v57, 3, v0
  v_bfe_u32 v56, v0, 5, 1
  v_lshl_add_u32 v56, v57, 1, v56
  v_add_u32 v56, 0, v56
  v_and_b32 v56, 7, v56
  v_bfe_u32 v58, v0, 4, 1
  v_lshl_add_u32 v56, v56, 1, v58
  v_bfe_u32 v58, v0, 2, 1
  v_lshl_add_u32 v56, v56, 1, v58
  s_lshl_b32 s7, s3, 5
  v_add_lshl_u32 v4, v56, s7, 2
  v_and_b32 v58, 7, v56
  s_lshl_b32 s7, s3, 4
  v_add_lshl_u32 v58, v58, s7, 4
  v_lshrrev_b32 v56, 3, v56
  v_lshl_add_u32 v84, v56, 2, v58
  v_lshrrev_b32 v56, 2, v0
  s_waitcnt vmcnt(6)
  s_mov_b32 s65, 134144
  buffer_load_dwordx4 a[140:143], v2, s[8:11], s65 offen nt
  s_waitcnt vmcnt(6)
  s_mov_b32 s65, 135168
  buffer_load_dwordx4 a[144:147], v2, s[8:11], s65 offen nt
  s_waitcnt vmcnt(6)
  s_mov_b32 s65, 136192
  buffer_load_dwordx4 a[148:151], v2, s[8:11], s65 offen nt
  s_waitcnt vmcnt(6)
  s_mov_b32 s65, 137216
  buffer_load_dwordx4 a[152:155], v2, s[8:11], s65 offen nt
  s_waitcnt vmcnt(6)
  s_mov_b32 s65, 138240
  buffer_load_dwordx4 a[156:159], v2, s[8:11], s65 offen nt
  s_waitcnt vmcnt(6)
  s_mov_b32 s65, 163840
  buffer_load_dwordx4 a[160:163], v2, s[8:11], s65 offen nt
  s_waitcnt vmcnt(6)
  s_mov_b32 s65, 164864
  buffer_load_dwordx4 a[164:167], v2, s[8:11], s65 offen nt
  s_waitcnt vmcnt(6)
  s_mov_b32 s65, 165888
  buffer_load_dwordx4 a[168:171], v2, s[8:11], s65 offen nt
  s_waitcnt vmcnt(6)
  s_mov_b32 s65, 166912
  buffer_load_dwordx4 a[172:175], v2, s[8:11], s65 offen nt
  s_waitcnt vmcnt(6)
  s_mov_b32 s65, 167936
  buffer_load_dwordx4 a[176:179], v2, s[8:11], s65 offen nt
  s_waitcnt vmcnt(6)
  s_mov_b32 s65, 168960
  buffer_load_dwordx4 a[180:183], v2, s[8:11], s65 offen nt
  s_waitcnt vmcnt(6)
  s_mov_b32 s65, 169984
  buffer_load_dwordx4 a[184:187], v2, s[8:11], s65 offen nt
  s_waitcnt vmcnt(6)
  s_mov_b32 s65, 171008
  buffer_load_dwordx4 a[188:191], v2, s[8:11], s65 offen nt
  s_waitcnt vmcnt(6)
  s_mov_b32 s65, 196608
  buffer_load_dwordx4 a[192:195], v2, s[8:11], s65 offen nt
  s_waitcnt vmcnt(6)
  s_mov_b32 s65, 197632
  buffer_load_dwordx4 a[196:199], v2, s[8:11], s65 offen nt
  s_waitcnt vmcnt(6)
  s_mov_b32 s65, 198656
  buffer_load_dwordx4 a[200:203], v2, s[8:11], s65 offen nt
  s_waitcnt vmcnt(6)
  s_mov_b32 s65, 199680
  buffer_load_dwordx4 a[204:207], v2, s[8:11], s65 offen nt
  s_waitcnt vmcnt(6)
  s_mov_b32 s65, 200704
  buffer_load_dwordx4 a[208:211], v2, s[8:11], s65 offen nt
  s_waitcnt vmcnt(6)
  s_mov_b32 s65, 201728
  buffer_load_dwordx4 a[212:215], v2, s[8:11], s65 offen nt
  s_waitcnt vmcnt(6)
  s_mov_b32 s65, 202752
  buffer_load_dwordx4 a[216:219], v2, s[8:11], s65 offen nt
  buffer_load_dword v54, v52, s[28:31], s75 offen sc1
  s_waitcnt vmcnt(7)
  s_mov_b32 s65, 203776
  buffer_load_dwordx4 a[220:223], v2, s[8:11], s65 offen nt
  s_waitcnt vmcnt(7)
  s_mov_b32 s65, 229376
  buffer_load_dwordx4 a[224:227], v2, s[8:11], s65 offen nt
  s_waitcnt vmcnt(7)
  s_mov_b32 s65, 230400
  buffer_load_dwordx4 a[228:231], v2, s[8:11], s65 offen nt
  s_waitcnt vmcnt(7)
  s_mov_b32 s65, 231424
  buffer_load_dwordx4 a[232:235], v2, s[8:11], s65 offen nt
  s_waitcnt vmcnt(7)
  s_mov_b32 s65, 232448
  buffer_load_dwordx4 a[236:239], v2, s[8:11], s65 offen nt
  s_waitcnt vmcnt(7)
  s_mov_b32 s65, 233472
  buffer_load_dwordx4 a[240:243], v2, s[8:11], s65 offen nt
  s_waitcnt vmcnt(7)
  s_mov_b32 s65, 234496
  buffer_load_dwordx4 a[244:247], v2, s[8:11], s65 offen nt
  s_waitcnt vmcnt(7)
  s_add_u32 s66, s66, 229376
  v_cmp_eq_u32 vcc, 0, v54
  s_cbranch_vccnz L_qslowG
L_qokG:
  buffer_load_dwordx4 v[64:67], v3, s[28:31], s66 offen sc1
  v_bfe_u32 v54, v0, 3, 2
  v_and_b32 v55, 7, v0
  v_lshl_add_u32 v54, v54, 5, v55
  v_bfe_u32 v55, v0, 5, 0
  v_lshl_add_u32 v54, v55, 4, v54
  s_lshl_b32 s7, s3, 9
  v_lshl_add_u32 v54, v54, 2, s7
  v_and_b32 v55, 3, v0
  v_lshl_add_u32 v55, v7, 2, v55
  v_lshlrev_b32 v55, 5, v55
  s_waitcnt vmcnt(7)
  s_mov_b32 s65, 235520
  buffer_load_dwordx4 a[248:251], v2, s[8:11], s65 offen nt
  s_waitcnt vmcnt(7)
  s_mov_b32 s65, 236544
  buffer_load_dwordx4 a[252:255], v2, s[8:11], s65 offen nt
  s_waitcnt vmcnt(7)
  s_mov_b32 s65, 0
  buffer_load_dwordx4 v[208:211], v63, s[12:15], s65 offen nt
  s_waitcnt vmcnt(7)
  s_mov_b32 s65, 1024
  buffer_load_dwordx4 v[212:215], v63, s[12:15], s65 offen nt
  s_waitcnt vmcnt(7)
  s_mov_b32 s65, 2048
  buffer_load_dwordx4 v[216:219], v63, s[12:15], s65 offen nt
  s_waitcnt vmcnt(7)
  s_mov_b32 s65, 3072
  buffer_load_dwordx4 v[220:223], v63, s[12:15], s65 offen nt
  s_waitcnt vmcnt(7)
  s_mov_b32 s65, 4096
  buffer_load_dwordx4 v[224:227], v63, s[12:15], s65 offen nt
  s_waitcnt vmcnt(7)
  v_mov_b32 v68, v64
  v_mov_b32 v69, v65
  v_mov_b32 v70, v66
  v_mov_b32 v71, v67
  v_permlane32_swap_b32 v64, v68
  v_permlane32_swap_b32 v65, v69
  v_permlane32_swap_b32 v66, v70
  v_permlane32_swap_b32 v67, v71
  v_add_f32 v64, v64, v68
  v_add_f32 v65, v65, v69
  v_add_f32 v66, v66, v70
  v_add_f32 v67, v67, v71
  s_cmp_lg_u32 s64, 0
  s_cbranch_scc1 L_qlocalG
L_qjoinG:
  ds_write_b32 v54, v64 offset:0
  ds_write_b32 v54, v65 offset:32
  ds_write_b32 v54, v66 offset:64
  ds_write_b32 v54, v67 offset:96
  s_mov_b32 s65, 5120
  buffer_load_dwordx4 v[228:231], v63, s[12:15], s65 offen nt
  s_waitcnt lgkmcnt(0)
  s_barrier
  ds_read_b128 v[176:179], v55 offset:0
  ds_read_b128 v[180:183], v55 offset:16
  ds_read_b128 v[184:187], v55 offset:512
  ds_read_b128 v[188:191], v55 offset:528
  ds_read_b128 v[192:195], v55 offset:1024
  ds_read_b128 v[196:199], v55 offset:1040
  ds_read_b128 v[200:203], v55 offset:1536
  ds_read_b128 v[204:207], v55 offset:1552
  s_waitcnt lgkmcnt(0)
  s_waitcnt vmcnt(6)
  s_mov_b32 s65, 6144
  buffer_load_dwordx4 v[232:235], v63, s[12:15], s65 offen nt
  v_pk_add_f32 v[176:177], v[176:177], v[184:185]
  v_pk_add_f32 v[192:193], v[192:193], v[200:201]
  v_pk_add_f32 v[176:177], v[176:177], v[192:193]
  v_pk_add_f32 v[178:179], v[178:179], v[186:187]
  v_pk_add_f32 v[194:195], v[194:195], v[202:203]
  v_pk_add_f32 v[178:179], v[178:179], v[194:195]
  v_pk_add_f32 v[180:181], v[180:181], v[188:189]
  v_pk_add_f32 v[196:197], v[196:197], v[204:205]
  v_pk_add_f32 v[180:181], v[180:181], v[196:197]
  v_pk_add_f32 v[182:183], v[182:183], v[190:191]
  v_pk_add_f32 v[198:199], v[198:199], v[206:207]
  v_pk_add_f32 v[182:183], v[182:183], v[198:199]
  v_cvt_pk_bf16_f32 v176, v176, v177
  v_cvt_pk_bf16_f32 v177, v178, v179
  v_cvt_pk_bf16_f32 v178, v180, v181
  v_cvt_pk_bf16_f32 v179, v182, v183
  s_mov_b32 s68, 0xf000f
  s_mov_b32 s69, 0xf000f
  v_cndmask_b32 v32, 0, v176, s[68:69]
  v_cndmask_b32 v33, 0, v177, s[68:69]
  v_cndmask_b32 v34, 0, v178, s[68:69]
  v_cndmask_b32 v35, 0, v179, s[68:69]
  s_mov_b32 s68, 0xf000f0
  s_mov_b32 s69, 0xf000f0
  v_cndmask_b32 v36, 0, v176, s[68:69]
  v_cndmask_b32 v37, 0, v177, s[68:69]
  v_cndmask_b32 v38, 0, v178, s[68:69]
  v_cndmask_b32 v39, 0, v179, s[68:69]
  s_mov_b32 s68, 0xf000f00
  s_mov_b32 s69, 0xf000f00
  v_cndmask_b32 v40, 0, v176, s[68:69]
  v_cndmask_b32 v41, 0, v177, s[68:69]
  v_cndmask_b32 v42, 0, v178, s[68:69]
  v_cndmask_b32 v43, 0, v179, s[68:69]
  s_mov_b32 s68, 0xf000f000
  s_mov_b32 s69, 0xf000f000
  v_cndmask_b32 v44, 0, v176, s[68:69]
  v_cndmask_b32 v45, 0, v177, s[68:69]
  v_cndmask_b32 v46, 0, v178, s[68:69]
  v_cndmask_b32 v47, 0, v179, s[68:69]
  s_mov_b32 s70, 0x22222222
  s_mov_b32 s71, 0x22222222
  s_mov_b32 s72, 0x44444444
  s_mov_b32 s73, 0x44444444
  s_mov_b32 s74, 0x88888888
  s_mov_b32 s75, 0x88888888
  v_mfma_f32_16x16x32_bf16 v[24:27], a[0:3], v[32:35], 0
  s_waitcnt vmcnt(6)
  s_mov_b32 s65, 7168
  buffer_load_dwordx4 v[236:239], v63, s[12:15], s65 offen nt
  v_mfma_f32_16x16x32_bf16 v[24:27], a[4:7], v[36:39], v[24:27]
  v_mfma_f32_16x16x32_bf16 v[24:27], a[8:11], v[40:43], v[24:27]
  v_mfma_f32_16x16x32_bf16 v[24:27], a[12:15], v[44:47], v[24:27]
  s_nop 4
  v_mfma_f32_16x16x32_bf16 v[28:31], a[16:19], v[32:35], 0
  v_mfma_f32_16x16x32_bf16 v[28:31], a[20:23], v[36:39], v[28:31]
  v_mfma_f32_16x16x32_bf16 v[28:31], a[24:27], v[40:43], v[28:31]
  v_mfma_f32_16x16x32_bf16 v[28:31], a[28:31], v[44:47], v[28:31]
  v_mov_b32_dpp v52, v24 quad_perm:[0,0,0,0] row_mask:0xf bank_mask:0xf
  v_add_f32_dpp v52, v25, v52 quad_perm:[1,1,1,1] row_mask:0xf bank_mask:0xf
  v_add_f32_dpp v52, v26, v52 quad_perm:[2,2,2,2] row_mask:0xf bank_mask:0xf
  v_add_f32_dpp v48, v27, v52 quad_perm:[3,3,3,3] row_mask:0xf bank_mask:0xf
  s_nop 0
  v_mfma_f32_16x16x32_bf16 v[24:27], a[32:35], v[32:35], 0
  v_mfma_f32_16x16x32_bf16 v[24:27], a[36:39], v[36:39], v[24:27]
  v_mfma_f32_16x16x32_bf16 v[24:27], a[40:43], v[40:43], v[24:27]
  v_mfma_f32_16x16x32_bf16 v[24:27], a[44:47], v[44:47], v[24:27]
  v_mov_b32_dpp v52, v28 quad_perm:[0,0,0,0] row_mask:0xf bank_mask:0xf
  v_add_f32_dpp v52, v29, v52 quad_perm:[1,1,1,1] row_mask:0xf bank_mask:0xf
  v_add_f32_dpp v52, v30, v52 quad_perm:[2,2,2,2] row_mask:0xf bank_mask:0xf
  v_add_f32_dpp v52, v31, v52 quad_perm:[3,3,3,3] row_mask:0xf bank_mask:0xf
  v_cndmask_b32 v48, v48, v52, s[70:71]
  s_waitcnt vmcnt(6)
  s_mov_b32 s65, 32768
  buffer_load_dwordx4 v[240:243], v63, s[12:15], s65 offen nt
  v_mfma_f32_16x16x32_bf16 v[28:31], a[48:51], v[32:35], 0
  v_mfma_f32_16x16x32_bf16 v[28:31], a[52:55], v[36:39], v[28:31]
  v_mfma_f32_16x16x32_bf16 v[28:31], a[56:59], v[40:43], v[28:31]
  v_mfma_f32_16x16x32_bf16 v[28:31], a[60:63], v[44:47], v[28:31]
  v_mov_b32_dpp v52, v24 quad_perm:[0,0,0,0] row_mask:0xf bank_mask:0xf
  v_add_f32_dpp v52, v25, v52 quad_perm:[1,1,1,1] row_mask:0xf bank_mask:0xf
  v_add_f32_dpp v52, v26, v52 quad_perm:[2,2,2,2] row_mask:0xf bank_mask:0xf
  v_add_f32_dpp v52, v27, v52 quad_perm:[3,3,3,3] row_mask:0xf bank_mask:0xf
  v_cndmask_b32 v48, v48, v52, s[72:73]
  v_mfma_f32_16x16x32_bf16 v[24:27], a[64:67], v[32:35], 0
  v_mfma_f32_16x16x32_bf16 v[24:27], a[68:71], v[36:39], v[24:27]
  v_mfma_f32_16x16x32_bf16 v[24:27], a[72:75], v[40:43], v[24:27]
  v_mfma_f32_16x16x32_bf16 v[24:27], a[76:79], v[44:47], v[24:27]
  v_mov_b32_dpp v52, v28 quad_perm:[0,0,0,0] row_mask:0xf bank_mask:0xf
  v_add_f32_dpp v52, v29, v52 quad_perm:[1,1,1,1] row_mask:0xf bank_mask:0xf
  v_add_f32_dpp v52, v30, v52 quad_perm:[2,2,2,2] row_mask:0xf bank_mask:0xf
  v_add_f32_dpp v52, v31, v52 quad_perm:[3,3,3,3] row_mask:0xf bank_mask:0xf
  v_cndmask_b32 v48, v48, v52, s[74:75]
  v_mfma_f32_16x16x32_bf16 v[28:31], a[80:83], v[32:35], 0
  v_mfma_f32_16x16x32_bf16 v[28:31], a[84:87], v[36:39], v[28:31]
  v_mfma_f32_16x16x32_bf16 v[28:31], a[88:91], v[40:43], v[28:31]
  v_mfma_f32_16x16x32_bf16 v[28:31], a[92:95], v[44:47], v[28:31]
  v_mov_b32_dpp v52, v24 quad_perm:[0,0,0,0] row_mask:0xf bank_mask:0xf
  s_waitcnt vmcnt(6)
  s_mov_b32 s65, 33792
  buffer_load_dwordx4 v[244:247], v63, s[12:15], s65 offen nt
  v_add_f32_dpp v52, v25, v52 quad_perm:[1,1,1,1] row_mask:0xf bank_mask:0xf
  v_add_f32_dpp v52, v26, v52 quad_perm:[2,2,2,2] row_mask:0xf bank_mask:0xf
  v_add_f32_dpp v49, v27, v52 quad_perm:[3,3,3,3] row_mask:0xf bank_mask:0xf
  s_nop 0
  v_mfma_f32_16x16x32_bf16 v[24:27], a[96:99], v[32:35], 0
  v_mfma_f32_16x16x32_bf16 v[24:27], a[100:103], v[36:39], v[24:27]
  v_mfma_f32_16x16x32_bf16 v[24:27], a[104:107], v[40:43], v[24:27]
  v_mfma_f32_16x16x32_bf16 v[24:27], a[108:111], v[44:47], v[24:27]
  v_mov_b32_dpp v52, v28 quad_perm:[0,0,0,0] row_mask:0xf bank_mask:0xf
  v_add_f32_dpp v52, v29, v52 quad_perm:[1,1,1,1] row_mask:0xf bank_mask:0xf
  v_add_f32_dpp v52, v30, v52 quad_perm:[2,2,2,2] row_mask:0xf bank_mask:0xf
  v_add_f32_dpp v52, v31, v52 quad_perm:[3,3,3,3] row_mask:0xf bank_mask:0xf
  v_cndmask_b32 v49, v49, v52, s[70:71]
  v_mfma_f32_16x16x32_bf16 v[28:31], a[112:115], v[32:35], 0
  v_mfma_f32_16x16x32_bf16 v[28:31], a[116:119], v[36:39], v[28:31]
  v_mfma_f32_16x16x32_bf16 v[28:31], a[120:123], v[40:43], v[28:31]
  v_mfma_f32_16x16x32_bf16 v[28:31], a[124:127], v[44:47], v[28:31]
  v_mov_b32_dpp v52, v24 quad_perm:[0,0,0,0] row_mask:0xf bank_mask:0xf
  v_add_f32_dpp v52, v25, v52 quad_perm:[1,1,1,1] row_mask:0xf bank_mask:0xf
  v_add_f32_dpp v52, v26, v52 quad_perm:[2,2,2,2] row_mask:0xf bank_mask:0xf
  v_add_f32_dpp v52, v27, v52 quad_perm:[3,3,3,3] row_mask:0xf bank_mask:0xf
  v_cndmask_b32 v49, v49, v52, s[72:73]
  v_mfma_f32_16x16x32_bf16 v[24:27], a[128:131], v[32:35], 0
  v_mfma_f32_16x16x32_bf16 v[24:27], a[132:135], v[36:39], v[24:27]
  v_mfma_f32_16x16x32_bf16 v[24:27], a[136:139], v[40:43], v[24:27]
  s_waitcnt vmcnt(6)
  s_mov_b32 s65, 34816
  buffer_load_dwordx4 v[248:251], v63, s[12:15], s65 offen nt
  v_mfma_f32_16x16x32_bf16 v[24:27], a[140:143], v[44:47], v[24:27]
  v_mov_b32_dpp v52, v28 quad_perm:[0,0,0,0] row_mask:0xf bank_mask:0xf
  v_add_f32_dpp v52, v29, v52 quad_perm:[1,1,1,1] row_mask:0xf bank_mask:0xf
  v_add_f32_dpp v52, v30, v52 quad_perm:[2,2,2,2] row_mask:0xf bank_mask:0xf
  v_add_f32_dpp v52, v31, v52 quad_perm:[3,3,3,3] row_mask:0xf bank_mask:0xf
  v_cndmask_b32 v49, v49, v52, s[74:75]
  v_mfma_f32_16x16x32_bf16 v[28:31], a[144:147], v[32:35], 0
  v_mfma_f32_16x16x32_bf16 v[28:31], a[148:151], v[36:39], v[28:31]
  v_mfma_f32_16x16x32_bf16 v[28:31], a[152:155], v[40:43], v[28:31]
  v_mfma_f32_16x16x32_bf16 v[28:31], a[156:159], v[44:47], v[28:31]
  v_mov_b32_dpp v52, v24 quad_perm:[0,0,0,0] row_mask:0xf bank_mask:0xf
  v_add_f32_dpp v52, v25, v52 quad_perm:[1,1,1,1] row_mask:0xf bank_mask:0xf
  v_add_f32_dpp v52, v26, v52 quad_perm:[2,2,2,2] row_mask:0xf bank_mask:0xf
  v_add_f32_dpp v50, v27, v52 quad_perm:[3,3,3,3] row_mask:0xf bank_mask:0xf
  s_nop 0
  v_mfma_f32_16x16x32_bf16 v[24:27], a[160:163], v[32:35], 0
  v_mfma_f32_16x16x32_bf16 v[24:27], a[164:167], v[36:39], v[24:27]
  v_mfma_f32_16x16x32_bf16 v[24:27], a[168:171], v[40:43], v[24:27]
  v_mfma_f32_16x16x32_bf16 v[24:27], a[172:175], v[44:47], v[24:27]
  v_mov_b32_dpp v52, v28 quad_perm:[0,0,0,0] row_mask:0xf bank_mask:0xf
  v_add_f32_dpp v52, v29, v52 quad_perm:[1,1,1,1] row_mask:0xf bank_mask:0xf
  v_add_f32_dpp v52, v30, v52 quad_perm:[2,2,2,2] row_mask:0xf bank_mask:0xf
  v_add_f32_dpp v52, v31, v52 quad_perm:[3,3,3,3] row_mask:0xf bank_mask:0xf
  v_cndmask_b32 v50, v50, v52, s[70:71]
  v_mfma_f32_16x16x32_bf16 v[28:31], a[176:179], v[32:35], 0
  v_mfma_f32_16x16x32_bf16 v[28:31], a[180:183], v[36:39], v[28:31]
  s_waitcnt vmcnt(6)
  s_mov_b32 s65, 35840
  buffer_load_dwordx4 v[252:255], v63, s[12:15], s65 offen nt
  v_mfma_f32_16x16x32_bf16 v[28:31], a[184:187], v[40:43], v[28:31]
  v_mfma_f32_16x16x32_bf16 v[28:31], a[188:191], v[44:47], v[28:31]
  v_mov_b32_dpp v52, v24 quad_perm:[0,0,0,0] row_mask:0xf bank_mask:0xf
  v_add_f32_dpp v52, v25, v52 quad_perm:[1,1,1,1] row_mask:0xf bank_mask:0xf
  v_add_f32_dpp v52, v26, v52 quad_perm:[2,2,2,2] row_mask:0xf bank_mask:0xf
  v_add_f32_dpp v52, v27, v52 quad_perm:[3,3,3,3] row_mask:0xf bank_mask:0xf
  v_cndmask_b32 v50, v50, v52, s[72:73]
  v_mfma_f32_16x16x32_bf16 v[24:27], a[192:195], v[32:35], 0
  v_mfma_f32_16x16x32_bf16 v[24:27], a[196:199], v[36:39], v[24:27]
  v_mfma_f32_16x16x32_bf16 v[24:27], a[200:203], v[40:43], v[24:27]
  v_mfma_f32_16x16x32_bf16 v[24:27], a[204:207], v[44:47], v[24:27]
  v_mov_b32_dpp v52, v28 quad_perm:[0,0,0,0] row_mask:0xf bank_mask:0xf
  v_add_f32_dpp v52, v29, v52 quad_perm:[1,1,1,1] row_mask:0xf bank_mask:0xf
  v_add_f32_dpp v52, v30, v52 quad_perm:[2,2,2,2] row_mask:0xf bank_mask:0xf
  v_add_f32_dpp v52, v31, v52 quad_perm:[3,3,3,3] row_mask:0xf bank_mask:0xf
  v_cndmask_b32 v50, v50, v52, s[74:75]
  v_mfma_f32_16x16x32_bf16 v[28:31], a[208:211], v[32:35], 0
  v_mfma_f32_16x16x32_bf16 v[28:31], a[212:215], v[36:39], v[28:31]
  v_mfma_f32_16x16x32_bf16 v[28:31], a[216:219], v[40:43], v[28:31]
  v_mfma_f32_16x16x32_bf16 v[28:31], a[220:223], v[44:47], v[28:31]
  v_mov_b32_dpp v52, v24 quad_perm:[0,0,0,0] row_mask:0xf bank_mask:0xf
  v_add_f32_dpp v52, v25, v52 quad_perm:[1,1,1,1] row_mask:0xf bank_mask:0xf
  v_add_f32_dpp v52, v26, v52 quad_perm:[2,2,2,2] row_mask:0xf bank_mask:0xf
  v_add_f32_dpp v51, v27, v52 quad_perm:[3,3,3,3] row_mask:0xf bank_mask:0xf
  s_nop 0
  v_mfma_f32_16x16x32_bf16 v[24:27], a[224:227], v[32:35], 0
  s_waitcnt vmcnt(6)
  s_mov_b32 s65, 36864
  buffer_load_dwordx4 a[0:3], v63, s[12:15], s65 offen nt
  v_mfma_f32_16x16x32_bf16 v[24:27], a[228:231], v[36:39], v[24:27]
  v_mfma_f32_16x16x32_bf16 v[24:27], a[232:235], v[40:43], v[24:27]
  v_mfma_f32_16x16x32_bf16 v[24:27], a[236:239], v[44:47], v[24:27]
  v_mov_b32_dpp v52, v28 quad_perm:[0,0,0,0] row_mask:0xf bank_mask:0xf
  v_add_f32_dpp v52, v29, v52 quad_perm:[1,1,1,1] row_mask:0xf bank_mask:0xf
  v_add_f32_dpp v52, v30, v52 quad_perm:[2,2,2,2] row_mask:0xf bank_mask:0xf
  v_add_f32_dpp v52, v31, v52 quad_perm:[3,3,3,3] row_mask:0xf bank_mask:0xf
  v_cndmask_b32 v51, v51, v52, s[70:71]
  v_mfma_f32_16x16x32_bf16 v[28:31], a[240:243], v[32:35], 0
  v_mfma_f32_16x16x32_bf16 v[28:31], a[244:247], v[36:39], v[28:31]
  v_mfma_f32_16x16x32_bf16 v[28:31], a[248:251], v[40:43], v[28:31]
  v_mfma_f32_16x16x32_bf16 v[28:31], a[252:255], v[44:47], v[28:31]
  v_mov_b32_dpp v52, v24 quad_perm:[0,0,0,0] row_mask:0xf bank_mask:0xf
  v_add_f32_dpp v52, v25, v52 quad_perm:[1,1,1,1] row_mask:0xf bank_mask:0xf
  v_add_f32_dpp v52, v26, v52 quad_perm:[2,2,2,2] row_mask:0xf bank_mask:0xf
  v_add_f32_dpp v52, v27, v52 quad_perm:[3,3,3,3] row_mask:0xf bank_mask:0xf
  v_cndmask_b32 v51, v51, v52, s[72:73]
  s_nop 3
  v_mov_b32_dpp v52, v28 quad_perm:[0,0,0,0] row_mask:0xf bank_mask:0xf
  v_add_f32_dpp v52, v29, v52 quad_perm:[1,1,1,1] row_mask:0xf bank_mask:0xf
  v_add_f32_dpp v52, v30, v52 quad_perm:[2,2,2,2] row_mask:0xf bank_mask:0xf
  v_add_f32_dpp v52, v31, v52 quad_perm:[3,3,3,3] row_mask:0xf bank_mask:0xf
  v_cndmask_b32 v51, v51, v52, s[74:75]
  v_cvt_pk_bf16_f32 v52, v48, v49
  v_lshlrev_b32 v54, 16, v52
  v_and_b32 v55, 0xffff0000, v52
  v_mul_f32 v54, 0x3db504f3, v54
  v_mul_f32 v55, 0x3db504f3, v55
  v_cvt_pk_bf16_f32 v52, v54, v55
  v_lshlrev_b32 v54, 16, v52
  s_waitcnt vmcnt(6)
  s_mov_b32 s65, 37888
  buffer_load_dwordx4 a[4:7], v63, s[12:15], s65 offen nt
  v_and_b32 v55, 0xffff0000, v52
  v_cvt_pk_bf16_f32 v52, v50, v51
  v_lshlrev_b32 v56, 16, v52
  v_and_b32 v57, 0xffff0000, v52
  v_mul_f32 v56, 0x3db504f3, v56
  v_mul_f32 v57, 0x3db504f3, v57
  v_cvt_pk_bf16_f32 v52, v56, v57
  v_lshlrev_b32 v56, 16, v52
  v_and_b32 v57, 0xffff0000, v52
  v_max_f32 v58, v54, v55
  v_max3_f32 v58, v58, v56, v57
  s_nop 1
  v_max_f32_dpp v58, v58, v58 quad_perm:[1,0,3,2] row_mask:0xf bank_mask:0xf
  s_nop 1
  v_max_f32_dpp v58, v58, v58 quad_perm:[2,3,0,1] row_mask:0xf bank_mask:0xf
  s_nop 1
  v_max_f32_dpp v58, v58, v58 row_half_mirror row_mask:0xf bank_mask:0xf
  s_nop 1
  v_max_f32_dpp v58, v58, v58 row_mirror row_mask:0xf bank_mask:0xf
  v_mov_b32 v52, v58
  s_nop 1
  v_permlane16_swap_b32 v58, v52
  s_nop 0
  v_max_f32 v58, v58, v52
  v_mov_b32 v52, v58
  s_nop 1
  v_permlane32_swap_b32 v58, v52
  s_nop 0
  v_max_f32 v58, v58, v52
  v_sub_f32 v48, v54, v58
  v_mul_f32 v48, 0x3fb8aa3b, v48
  v_exp_f32 v48, v48
  v_sub_f32 v49, v55, v58
  v_mul_f32 v49, 0x3fb8aa3b, v49
  v_exp_f32 v49, v49
  v_sub_f32 v50, v56, v58
  v_mul_f32 v50, 0x3fb8aa3b, v50
  v_exp_f32 v50, v50
  s_waitcnt vmcnt(6)
  s_mov_b32 s65, 38912
  buffer_load_dwordx4 a[8:11], v63, s[12:15], s65 offen nt
  v_sub_f32 v51, v57, v58
  v_mul_f32 v51, 0x3fb8aa3b, v51
  v_exp_f32 v51, v51
  s_nop 0
  v_add_f32 v59, v48, v49
  v_add_f32 v52, v50, v51
  v_add_f32 v59, v59, v52
  s_nop 1
  v_add_f32_dpp v59, v59, v59 quad_perm:[1,0,3,2] row_mask:0xf bank_mask:0xf
  s_nop 1
  v_add_f32_dpp v59, v59, v59 quad_perm:[2,3,0,1] row_mask:0xf bank_mask:0xf
  s_nop 1
  v_add_f32_dpp v59, v59, v59 row_half_mirror row_mask:0xf bank_mask:0xf
  s_nop 1
  v_add_f32_dpp v59, v59, v59 row_mirror row_mask:0xf bank_mask:0xf
  v_mov_b32 v52, v59
  s_nop 1
  v_permlane16_swap_b32 v59, v52
  s_nop 0
  v_add_f32 v59, v59, v52
  v_mov_b32 v52, v59
  s_nop 1
  v_permlane32_swap_b32 v59, v52
  s_nop 0
  v_add_f32 v59, v59, v52
  s_lshl_b32 s7, s3, 3
  v_mov_b32 v52, s7
  ds_write_b64 v52, v[58:59] offset:2048
  s_mov_b32 s65, 39936
  buffer_load_dwordx4 a[12:15], v63, s[12:15], s65 offen nt
  s_waitcnt lgkmcnt(0)
  s_barrier
  v_mov_b32 v52, 0
  ds_read_b128 v[64:67], v52 offset:2048
  ds_read_b128 v[68:71], v52 offset:2064
  s_waitcnt lgkmcnt(0)
  v_max_f32 v58, v64, v66
  v_max3_f32 v58, v58, v68, v70
  v_sub_f32 v64, v64, v58
  s_waitcnt vmcnt(6)
  s_mov_b32 s65, 65536
  buffer_load_dwordx4 a[16:19], v63, s[12:15], s65 offen nt
  v_mul_f32 v64, 0x3fb8aa3b, v64
  v_exp_f32 v64, v64
  v_sub_f32 v66, v66, v58
  v_mul_f32 v66, 0x3fb8aa3b, v66
  v_exp_f32 v66, v66
  v_sub_f32 v68, v68, v58
  v_mul_f32 v68, 0x3fb8aa3b, v68
  v_exp_f32 v68, v68
  v_sub_f32 v70, v70, v58
  v_mul_f32 v70, 0x3fb8aa3b, v70
  v_exp_f32 v70, v70
  v_sub_f32 v48, v54, v58
  v_mul_f32 v48, 0x3fb8aa3b, v48
  v_exp_f32 v48, v48
  v_sub_f32 v49, v55, v58
  v_mul_f32 v49, 0x3fb8aa3b, v49
  v_exp_f32 v49, v49
  v_sub_f32 v50, v56, v58
  v_mul_f32 v50, 0x3fb8aa3b, v50
  v_exp_f32 v50, v50
  v_sub_f32 v51, v57, v58
  v_mul_f32 v51, 0x3fb8aa3b, v51
  v_exp_f32 v51, v51
  v_mul_f32 v59, v64, v65
  v_fmac_f32 v59, v66, v67
  v_fmac_f32 v59, v68, v69
  v_fmac_f32 v59, v70, v71
  v_rcp_f32 v59, v59
  s_nop 0
  v_mul_f32 v48, v48, v59
  v_mul_f32 v49, v49, v59
  v_mul_f32 v50, v50, v59
  v_mul_f32 v51, v51, v59
  v_cvt_pk_bf16_f32 v48, v48, v48
  v_cvt_pk_bf16_f32 v49, v49, v49
  v_cvt_pk_bf16_f32 v50, v50, v50
  v_cvt_pk_bf16_f32 v51, v51, v51
  s_and_b32 s70, s2, 7
  s_lshr_b32 s71, s2, 3
  s_min_u32 s72, s70, 3
  s_mul_i32 s73, s70, 3
  s_add_u32 s73, s73, s72
  s_cmp_lt_u32 s70, 3
  s_cselect_b32 s72, 4, 3
  s_sub_u32 s7, s5, 6
  s_cmp_eq_u32 s3, 2
  s_cselect_b32 s7, s7, s5
  s_lshr_b32 s78, s7, 1
  s_lshl_b32 s78, s78, 7
  s_and_b32 s74, s7, 1
  s_add_u32 s78, s78, s74
  s_add_u32 s78, s78, 98304
  s_add_u32 s7, s7, 8
  s_cmp_eq_u32 s3, 0
  s_cselect_b32 s74, s70, s7
  s_lshl_b32 s74, s74, 7
  s_add_u32 s74, s74, 94208
  s_lshl_b32 s67, s5, 12
  s_mov_b32 s76, 1
  s_mov_b32 s68, 0x88888888
  s_mov_b32 s69, 0x88888888
  s_mul_i32 s7, s3, 5120
  v_add_u32 v15, s7, v90
  v_mov_b32 v14, v4
  s_and_b32 s75, s71, 7
  s_lshl_b32 s7, s70, 3
  s_add_u32 s75, s75, s7
  s_lshl_b32 s75, s75, 9
  s_add_u32 s75, s75, 196608
  v_and_b32_dpp v16, v48, v8 row_newbcast:0 row_mask:0xf bank_mask:0xf
  v_and_b32_dpp v17, v48, v9 row_newbcast:0 row_mask:0xf bank_mask:0xf
  v_and_b32_dpp v18, v48, v10 row_newbcast:0 row_mask:0xf bank_mask:0xf
  v_and_b32_dpp v19, v48, v11 row_newbcast:0 row_mask:0xf bank_mask:0xf
  s_nop 1
  v_mfma_f32_16x16x32_bf16 v[24:27], v[208:211], v[16:19], 0
  v_and_b32_dpp v20, v48, v8 row_newbcast:4 row_mask:0xf bank_mask:0xf
  v_and_b32_dpp v21, v48, v9 row_newbcast:4 row_mask:0xf bank_mask:0xf
  v_and_b32_dpp v22, v48, v10 row_newbcast:4 row_mask:0xf bank_mask:0xf
  v_and_b32_dpp v23, v48, v11 row_newbcast:4 row_mask:0xf bank_mask:0xf
  s_nop 1
  v_mfma_f32_16x16x32_bf16 v[24:27], v[212:215], v[20:23], v[24:27]
  v_and_b32_dpp v16, v48, v8 row_newbcast:8 row_mask:0xf bank_mask:0xf
  v_and_b32_dpp v17, v48, v9 row_newbcast:8 row_mask:0xf bank_mask:0xf
  v_and_b32_dpp v18, v48, v10 row_newbcast:8 row_mask:0xf bank_mask:0xf
  v_and_b32_dpp v19, v48, v11 row_newbcast:8 row_mask:0xf bank_mask:0xf
  s_nop 1
  v_mfma_f32_16x16x32_bf16 v[24:27], v[216:219], v[16:19], v[24:27]
  s_waitcnt vmcnt(6)
  s_mov_b32 s65, 66560
  buffer_load_dwordx4 a[20:23], v63, s[12:15], s65 offen nt
  v_and_b32_dpp v20, v48, v8 row_newbcast:12 row_mask:0xf bank_mask:0xf
  v_and_b32_dpp v21, v48, v9 row_newbcast:12 row_mask:0xf bank_mask:0xf
  v_and_b32_dpp v22, v48, v10 row_newbcast:12 row_mask:0xf bank_mask:0xf
  v_and_b32_dpp v23, v48, v11 row_newbcast:12 row_mask:0xf bank_mask:0xf
  s_nop 1
  v_mfma_f32_16x16x32_bf16 v[24:27], v[220:223], v[20:23], v[24:27]
  v_and_b32_dpp v16, v48, v8 row_newbcast:1 row_mask:0xf bank_mask:0xf
  v_and_b32_dpp v17, v48, v9 row_newbcast:1 row_mask:0xf bank_mask:0xf
  v_and_b32_dpp v18, v48, v10 row_newbcast:1 row_mask:0xf bank_mask:0xf
  v_and_b32_dpp v19, v48, v11 row_newbcast:1 row_mask:0xf bank_mask:0xf
  s_nop 1
  v_mfma_f32_16x16x32_bf16 v[24:27], v[224:227], v[16:19], v[24:27]
  v_and_b32_dpp v20, v48, v8 row_newbcast:5 row_mask:0xf bank_mask:0xf
  v_and_b32_dpp v21, v48, v9 row_newbcast:5 row_mask:0xf bank_mask:0xf
  v_and_b32_dpp v22, v48, v10 row_newbcast:5 row_mask:0xf bank_mask:0xf
  v_and_b32_dpp v23, v48, v11 row_newbcast:5 row_mask:0xf bank_mask:0xf
  s_nop 1
  v_mfma_f32_16x16x32_bf16 v[24:27], v[228:231], v[20:23], v[24:27]
  s_waitcnt vmcnt(6)
  s_mov_b32 s65, 67584
  buffer_load_dwordx4 a[24:27], v63, s[12:15], s65 offen nt
  v_and_b32_dpp v16, v48, v8 row_newbcast:9 row_mask:0xf bank_mask:0xf
  v_and_b32_dpp v17, v48, v9 row_newbcast:9 row_mask:0xf bank_mask:0xf
  v_and_b32_dpp v18, v48, v10 row_newbcast:9 row_mask:0xf bank_mask:0xf
  v_and_b32_dpp v19, v48, v11 row_newbcast:9 row_mask:0xf bank_mask:0xf
  s_nop 1
  v_mfma_f32_16x16x32_bf16 v[24:27], v[232:235], v[16:19], v[24:27]
  v_and_b32_dpp v20, v48, v8 row_newbcast:13 row_mask:0xf bank_mask:0xf
  v_and_b32_dpp v21, v48, v9 row_newbcast:13 row_mask:0xf bank_mask:0xf
  v_and_b32_dpp v22, v48, v10 row_newbcast:13 row_mask:0xf bank_mask:0xf
  v_and_b32_dpp v23, v48, v11 row_newbcast:13 row_mask:0xf bank_mask:0xf
  s_nop 1
  v_mfma_f32_16x16x32_bf16 v[24:27], v[236:239], v[20:23], v[24:27]
  v_and_b32_dpp v16, v48, v8 row_newbcast:2 row_mask:0xf bank_mask:0xf
  v_and_b32_dpp v17, v48, v9 row_newbcast:2 row_mask:0xf bank_mask:0xf
  v_and_b32_dpp v18, v48, v10 row_newbcast:2 row_mask:0xf bank_mask:0xf
  v_and_b32_dpp v19, v48, v11 row_newbcast:2 row_mask:0xf bank_mask:0xf
  s_nop 1
  v_mfma_f32_16x16x32_bf16 v[24:27], v[240:243], v[16:19], v[24:27]
  s_waitcnt vmcnt(6)
  s_mov_b32 s65, 68608
  buffer_load_dwordx4 a[28:31], v63, s[12:15], s65 offen nt
  v_and_b32_dpp v20, v48, v8 row_newbcast:6 row_mask:0xf bank_mask:0xf
  v_and_b32_dpp v21, v48, v9 row_newbcast:6 row_mask:0xf bank_mask:0xf
  v_and_b32_dpp v22, v48, v10 row_newbcast:6 row_mask:0xf bank_mask:0xf
  v_and_b32_dpp v23, v48, v11 row_newbcast:6 row_mask:0xf bank_mask:0xf
  s_nop 1
  v_mfma_f32_16x16x32_bf16 v[24:27], v[244:247], v[20:23], v[24:27]
  v_and_b32_dpp v16, v48, v8 row_newbcast:10 row_mask:0xf bank_mask:0xf
  v_and_b32_dpp v17, v48, v9 row_newbcast:10 row_mask:0xf bank_mask:0xf
  v_and_b32_dpp v18, v48, v10 row_newbcast:10 row_mask:0xf bank_mask:0xf
  v_and_b32_dpp v19, v48, v11 row_newbcast:10 row_mask:0xf bank_mask:0xf
  s_nop 1
  v_mfma_f32_16x16x32_bf16 v[24:27], v[248:251], v[16:19], v[24:27]
  v_and_b32_dpp v20, v48, v8 row_newbcast:14 row_mask:0xf bank_mask:0xf
  v_and_b32_dpp v21, v48, v9 row_newbcast:14 row_mask:0xf bank_mask:0xf
  v_and_b32_dpp v22, v48, v10 row_newbcast:14 row_mask:0xf bank_mask:0xf
  v_and_b32_dpp v23, v48, v11 row_newbcast:14 row_mask:0xf bank_mask:0xf
  s_nop 1
  v_mfma_f32_16x16x32_bf16 v[24:27], v[252:255], v[20:23], v[24:27]
  s_waitcnt vmcnt(6)
  s_mov_b32 s65, 69632
  buffer_load_dwordx4 a[32:35], v63, s[12:15], s65 offen nt
  s_lshl_b32 s7, s71, 2
  s_add_u32 s7, s7, s3
  s_sub_u32 s7, s7, 4
  s_cmp_lt_u32 s7, 2
  s_cbranch_scc0 L_nocpt
  s_getpc_b64 s[34:35]
L_pct:
  s_sub_u32 s34, s34, L_pct-L_finN
  s_subb_u32 s35, s35, 0
  s_mul_i32 s7, s7, L_finG-L_finN
  v_lshl_add_u32 v52, v1, 7, s7
  v_min_u32 v52, L_last-L_finN-4, v52
  global_load_dword v95, v52, s[34:35]
L_nocpt:
  v_and_b32_dpp v16, v48, v8 row_newbcast:3 row_mask:0xf bank_mask:0xf
  v_and_b32_dpp v17, v48, v9 row_newbcast:3 row_mask:0xf bank_mask:0xf
  v_and_b32_dpp v18, v48, v10 row_newbcast:3 row_mask:0xf bank_mask:0xf
  v_and_b32_dpp v19, v48, v11 row_newbcast:3 row_mask:0xf bank_mask:0xf
  s_nop 1
  v_mfma_f32_16x16x32_bf16 v[24:27], a[0:3], v[16:19], v[24:27]
  v_and_b32_dpp v20, v48, v8 row_newbcast:7 row_mask:0xf bank_mask:0xf
  v_and_b32_dpp v21, v48, v9 row_newbcast:7 row_mask:0xf bank_mask:0xf
  v_and_b32_dpp v22, v48, v10 row_newbcast:7 row_mask:0xf bank_mask:0xf
  v_and_b32_dpp v23, v48, v11 row_newbcast:7 row_mask:0xf bank_mask:0xf
  s_nop 1
  v_mfma_f32_16x16x32_bf16 v[24:27], a[4:7], v[20:23], v[24:27]
  v_and_b32_dpp v16, v48, v8 row_newbcast:11 row_mask:0xf bank_mask:0xf
  v_and_b32_dpp v17, v48, v9 row_newbcast:11 row_mask:0xf bank_mask:0xf
  v_and_b32_dpp v18, v48, v10 row_newbcast:11 row_mask:0xf bank_mask:0xf
  v_and_b32_dpp v19, v48, v11 row_newbcast:11 row_mask:0xf bank_mask:0xf
  s_waitcnt vmcnt(6)
  s_nop 0
  v_mfma_f32_16x16x32_bf16 v[24:27], a[8:11], v[16:19], v[24:27]
  s_mov_b32 s65, 70656
  buffer_load_dwordx4 a[36:39], v63, s[12:15], s65 offen nt
  v_and_b32_dpp v20, v48, v8 row_newbcast:15 row_mask:0xf bank_mask:0xf
  v_and_b32_dpp v21, v48, v9 row_newbcast:15 row_mask:0xf bank_mask:0xf
  v_and_b32_dpp v22, v48, v10 row_newbcast:15 row_mask:0xf bank_mask:0xf
  v_and_b32_dpp v23, v48, v11 row_newbcast:15 row_mask:0xf bank_mask:0xf
  s_waitcnt vmcnt(6)
  s_nop 0
  v_mfma_f32_16x16x32_bf16 v[24:27], a[12:15], v[20:23], v[24:27]
  s_mov_b32 s65, 71680
  buffer_load_dwordx4 a[40:43], v63, s[12:15], s65 offen nt
  v_and_b32_dpp v16, v49, v8 row_newbcast:0 row_mask:0xf bank_mask:0xf
  v_and_b32_dpp v17, v49, v9 row_newbcast:0 row_mask:0xf bank_mask:0xf
  v_and_b32_dpp v18, v49, v10 row_newbcast:0 row_mask:0xf bank_mask:0xf
  v_and_b32_dpp v19, v49, v11 row_newbcast:0 row_mask:0xf bank_mask:0xf
  s_waitcnt vmcnt(6)
  s_nop 0
  v_mfma_f32_16x16x32_bf16 v[24:27], a[16:19], v[16:19], v[24:27]
  s_mov_b32 s65, 72704
  buffer_load_dwordx4 a[44:47], v63, s[12:15], s65 offen nt
  v_and_b32_dpp v20, v49, v8 row_newbcast:4 row_mask:0xf bank_mask:0xf
  v_and_b32_dpp v21, v49, v9 row_newbcast:4 row_mask:0xf bank_mask:0xf
  v_and_b32_dpp v22, v49, v10 row_newbcast:4 row_mask:0xf bank_mask:0xf
  v_and_b32_dpp v23, v49, v11 row_newbcast:4 row_mask:0xf bank_mask:0xf
  s_waitcnt vmcnt(6)
  s_nop 0
  v_mfma_f32_16x16x32_bf16 v[24:27], a[20:23], v[20:23], v[24:27]
  s_mov_b32 s65, 98304
  buffer_load_dwordx4 a[48:51], v63, s[12:15], s65 offen nt
  v_and_b32_dpp v16, v49, v8 row_newbcast:8 row_mask:0xf bank_mask:0xf
  v_and_b32_dpp v17, v49, v9 row_newbcast:8 row_mask:0xf bank_mask:0xf
  v_and_b32_dpp v18, v49, v10 row_newbcast:8 row_mask:0xf bank_mask:0xf
  v_and_b32_dpp v19, v49, v11 row_newbcast:8 row_mask:0xf bank_mask:0xf
  s_waitcnt vmcnt(6)
  s_nop 0
  v_mfma_f32_16x16x32_bf16 v[24:27], a[24:27], v[16:19], v[24:27]
  s_mov_b32 s65, 99328
  buffer_load_dwordx4 a[52:55], v63, s[12:15], s65 offen nt
  v_and_b32_dpp v20, v49, v8 row_newbcast:12 row_mask:0xf bank_mask:0xf
  v_and_b32_dpp v21, v49, v9 row_newbcast:12 row_mask:0xf bank_mask:0xf
  v_and_b32_dpp v22, v49, v10 row_newbcast:12 row_mask:0xf bank_mask:0xf
  v_and_b32_dpp v23, v49, v11 row_newbcast:12 row_mask:0xf bank_mask:0xf
  s_waitcnt vmcnt(6)
  s_nop 0
  v_mfma_f32_16x16x32_bf16 v[24:27], a[28:31], v[20:23], v[24:27]
  s_mov_b32 s65, 100352
  buffer_load_dwordx4 a[56:59], v63, s[12:15], s65 offen nt
  v_and_b32_dpp v16, v49, v8 row_newbcast:1 row_mask:0xf bank_mask:0xf
  v_and_b32_dpp v17, v49, v9 row_newbcast:1 row_mask:0xf bank_mask:0xf
  v_and_b32_dpp v18, v49, v10 row_newbcast:1 row_mask:0xf bank_mask:0xf
  v_and_b32_dpp v19, v49, v11 row_newbcast:1 row_mask:0xf bank_mask:0xf
  s_waitcnt vmcnt(6)
  s_nop 0
  v_mfma_f32_16x16x32_bf16 v[24:27], a[32:35], v[16:19], v[24:27]
  s_mov_b32 s65, 101376
  buffer_load_dwordx4 a[60:63], v63, s[12:15], s65 offen nt
  v_and_b32_dpp v20, v49, v8 row_newbcast:5 row_mask:0xf bank_mask:0xf
  v_and_b32_dpp v21, v49, v9 row_newbcast:5 row_mask:0xf bank_mask:0xf
  v_and_b32_dpp v22, v49, v10 row_newbcast:5 row_mask:0xf bank_mask:0xf
  v_and_b32_dpp v23, v49, v11 row_newbcast:5 row_mask:0xf bank_mask:0xf
  s_waitcnt vmcnt(6)
  s_nop 0
  v_mfma_f32_16x16x32_bf16 v[24:27], a[36:39], v[20:23], v[24:27]
  s_mov_b32 s65, 102400
  buffer_load_dwordx4 a[64:67], v63, s[12:15], s65 offen nt
  v_and_b32_dpp v16, v49, v8 row_newbcast:9 row_mask:0xf bank_mask:0xf
  v_and_b32_dpp v17, v49, v9 row_newbcast:9 row_mask:0xf bank_mask:0xf
  v_and_b32_dpp v18, v49, v10 row_newbcast:9 row_mask:0xf bank_mask:0xf
  v_and_b32_dpp v19, v49, v11 row_newbcast:9 row_mask:0xf bank_mask:0xf
  s_waitcnt vmcnt(6)
  s_nop 0
  v_mfma_f32_16x16x32_bf16 v[24:27], a[40:43], v[16:19], v[24:27]
  s_mov_b32 s65, 103424
  buffer_load_dwordx4 a[68:71], v63, s[12:15], s65 offen nt
  s_mov_b32 s65, 104448
  buffer_load_dwordx4 a[72:75], v63, s[12:15], s65 offen nt
  v_and_b32_dpp v20, v49, v8 row_newbcast:13 row_mask:0xf bank_mask:0xf
  v_and_b32_dpp v21, v49, v9 row_newbcast:13 row_mask:0xf bank_mask:0xf
  v_and_b32_dpp v22, v49, v10 row_newbcast:13 row_mask:0xf bank_mask:0xf
  v_and_b32_dpp v23, v49, v11 row_newbcast:13 row_mask:0xf bank_mask:0xf
  s_waitcnt vmcnt(7)
  s_nop 0
  v_mfma_f32_16x16x32_bf16 v[24:27], a[44:47], v[20:23], v[24:27]
  s_mov_b32 s65, 105472
  buffer_load_dwordx4 a[76:79], v63, s[12:15], s65 offen nt
  v_and_b32_dpp v16, v49, v8 row_newbcast:2 row_mask:0xf bank_mask:0xf
  v_and_b32_dpp v17, v49, v9 row_newbcast:2 row_mask:0xf bank_mask:0xf
  v_and_b32_dpp v18, v49, v10 row_newbcast:2 row_mask:0xf bank_mask:0xf
  v_and_b32_dpp v19, v49, v11 row_newbcast:2 row_mask:0xf bank_mask:0xf
  s_waitcnt vmcnt(7)
  s_nop 0
  v_mfma_f32_16x16x32_bf16 v[24:27], a[48:51], v[16:19], v[24:27]
  s_mov_b32 s65, 131072
  buffer_load_dwordx4 a[80:83], v63, s[12:15], s65 offen nt
  v_and_b32_dpp v20, v49, v8 row_newbcast:6 row_mask:0xf bank_mask:0xf
  v_and_b32_dpp v21, v49, v9 row_newbcast:6 row_mask:0xf bank_mask:0xf
  v_and_b32_dpp v22, v49, v10 row_newbcast:6 row_mask:0xf bank_mask:0xf
  v_and_b32_dpp v23, v49, v11 row_newbcast:6 row_mask:0xf bank_mask:0xf
  s_waitcnt vmcnt(7)
  s_nop 0
  v_mfma_f32_16x16x32_bf16 v[24:27], a[52:55], v[20:23], v[24:27]
  s_mov_b32 s65, 132096
  buffer_load_dwordx4 a[84:87], v63, s[12:15], s65 offen nt
  v_and_b32_dpp v16, v49, v8 row_newbcast:10 row_mask:0xf bank_mask:0xf
  v_and_b32_dpp v17, v49, v9 row_newbcast:10 row_mask:0xf bank_mask:0xf
  v_and_b32_dpp v18, v49, v10 row_newbcast:10 row_mask:0xf bank_mask:0xf
  v_and_b32_dpp v19, v49, v11 row_newbcast:10 row_mask:0xf bank_mask:0xf
  s_waitcnt vmcnt(7)
  s_nop 0
  v_mfma_f32_16x16x32_bf16 v[24:27], a[56:59], v[16:19], v[24:27]
  s_mov_b32 s65, 133120
  buffer_load_dwordx4 a[88:91], v63, s[12:15], s65 offen nt
  v_and_b32_dpp v20, v49, v8 row_newbcast:14 row_mask:0xf bank_mask:0xf
  v_and_b32_dpp v21, v49, v9 row_newbcast:14 row_mask:0xf bank_mask:0xf
  v_and_b32_dpp v22, v49, v10 row_newbcast:14 row_mask:0xf bank_mask:0xf
  v_and_b32_dpp v23, v49, v11 row_newbcast:14 row_mask:0xf bank_mask:0xf
  s_waitcnt vmcnt(7)
  s_nop 0
  v_mfma_f32_16x16x32_bf16 v[24:27], a[60:63], v[20:23], v[24:27]
  s_mov_b32 s65, 134144
  buffer_load_dwordx4 a[92:95], v63, s[12:15], s65 offen nt
  v_and_b32_dpp v16, v49, v8 row_newbcast:3 row_mask:0xf bank_mask:0xf
  v_and_b32_dpp v17, v49, v9 row_newbcast:3 row_mask:0xf bank_mask:0xf
  v_and_b32_dpp v18, v49, v10 row_newbcast:3 row_mask:0xf bank_mask:0xf
  v_and_b32_dpp v19, v49, v11 row_newbcast:3 row_mask:0xf bank_mask:0xf
  s_waitcnt vmcnt(7)
  s_nop 0
  v_mfma_f32_16x16x32_bf16 v[24:27], a[64:67], v[16:19], v[24:27]
  s_mov_b32 s65, 135168
  buffer_load_dwordx4 a[96:99], v63, s[12:15], s65 offen nt
  s_load_dwordx2 s[34:35], s[60:61], 0x80
  v_and_b32_dpp v20, v49, v8 row_newbcast:7 row_mask:0xf bank_mask:0xf
  v_and_b32_dpp v21, v49, v9 row_newbcast:7 row_mask:0xf bank_mask:0xf
  v_and_b32_dpp v22, v49, v10 row_newbcast:7 row_mask:0xf bank_mask:0xf
  v_and_b32_dpp v23, v49, v11 row_newbcast:7 row_mask:0xf bank_mask:0xf
  s_waitcnt vmcnt(7)
  s_nop 0
  v_mfma_f32_16x16x32_bf16 v[24:27], a[68:71], v[20:23], v[24:27]
  s_mov_b32 s65, 136192
  buffer_load_dwordx4 a[100:103], v63, s[12:15], s65 offen nt
  v_and_b32_dpp v16, v49, v8 row_newbcast:11 row_mask:0xf bank_mask:0xf
  v_and_b32_dpp v17, v49, v9 row_newbcast:11 row_mask:0xf bank_mask:0xf
  v_and_b32_dpp v18, v49, v10 row_newbcast:11 row_mask:0xf bank_mask:0xf
  v_and_b32_dpp v19, v49, v11 row_newbcast:11 row_mask:0xf bank_mask:0xf
  s_waitcnt vmcnt(7)
  s_nop 0
  v_mfma_f32_16x16x32_bf16 v[24:27], a[72:75], v[16:19], v[24:27]
  s_mov_b32 s65, 137216
  buffer_load_dwordx4 a[104:107], v63, s[12:15], s65 offen nt
  v_and_b32_dpp v20, v49, v8 row_newbcast:15 row_mask:0xf bank_mask:0xf
  v_and_b32_dpp v21, v49, v9 row_newbcast:15 row_mask:0xf bank_mask:0xf
  v_and_b32_dpp v22, v49, v10 row_newbcast:15 row_mask:0xf bank_mask:0xf
  v_and_b32_dpp v23, v49, v11 row_newbcast:15 row_mask:0xf bank_mask:0xf
  s_waitcnt vmcnt(7)
  s_nop 0
  v_mfma_f32_16x16x32_bf16 v[24:27], a[76:79], v[20:23], v[24:27]
  s_mov_b32 s65, 138240
  buffer_load_dwordx4 a[108:111], v63, s[12:15], s65 offen nt
  v_and_b32_dpp v16, v50, v8 row_newbcast:0 row_mask:0xf bank_mask:0xf
  v_and_b32_dpp v17, v50, v9 row_newbcast:0 row_mask:0xf bank_mask:0xf
  v_and_b32_dpp v18, v50, v10 row_newbcast:0 row_mask:0xf bank_mask:0xf
  v_and_b32_dpp v19, v50, v11 row_newbcast:0 row_mask:0xf bank_mask:0xf
  s_waitcnt vmcnt(7)
  s_nop 0
  v_mfma_f32_16x16x32_bf16 v[24:27], a[80:83], v[16:19], v[24:27]
  s_mov_b32 s65, 163840
  buffer_load_dwordx4 a[112:115], v63, s[12:15], s65 offen nt
  v_and_b32_dpp v20, v50, v8 row_newbcast:4 row_mask:0xf bank_mask:0xf
  v_and_b32_dpp v21, v50, v9 row_newbcast:4 row_mask:0xf bank_mask:0xf
  v_and_b32_dpp v22, v50, v10 row_newbcast:4 row_mask:0xf bank_mask:0xf
  v_and_b32_dpp v23, v50, v11 row_newbcast:4 row_mask:0xf bank_mask:0xf
  s_waitcnt vmcnt(7)
  s_nop 0
  v_mfma_f32_16x16x32_bf16 v[24:27], a[84:87], v[20:23], v[24:27]
  s_mov_b32 s65, 164864
  buffer_load_dwordx4 a[116:119], v63, s[12:15], s65 offen nt
  v_and_b32_dpp v16, v50, v8 row_newbcast:8 row_mask:0xf bank_mask:0xf
  v_and_b32_dpp v17, v50, v9 row_newbcast:8 row_mask:0xf bank_mask:0xf
  v_and_b32_dpp v18, v50, v10 row_newbcast:8 row_mask:0xf bank_mask:0xf
  v_and_b32_dpp v19, v50, v11 row_newbcast:8 row_mask:0xf bank_mask:0xf
  s_waitcnt vmcnt(7)
  s_nop 0
  v_mfma_f32_16x16x32_bf16 v[24:27], a[88:91], v[16:19], v[24:27]
  s_mov_b32 s65, 165888
  buffer_load_dwordx4 a[120:123], v63, s[12:15], s65 offen nt
L_ichkG:
  s_waitcnt lgkmcnt(0)
  s_orn2_b32 s35, s35, 0xff
  s_and_b32 s34, s34, s35
  s_cmp_eq_u32 s34, -1
  s_cbranch_scc0 L_islowG
  v_and_b32_dpp v20, v50, v8 row_newbcast:12 row_mask:0xf bank_mask:0xf
  v_and_b32_dpp v21, v50, v9 row_newbcast:12 row_mask:0xf bank_mask:0xf
  v_and_b32_dpp v22, v50, v10 row_newbcast:12 row_mask:0xf bank_mask:0xf
  v_and_b32_dpp v23, v50, v11 row_newbcast:12 row_mask:0xf bank_mask:0xf
  s_waitcnt vmcnt(7)
  s_nop 0
  v_mfma_f32_16x16x32_bf16 v[24:27], a[92:95], v[20:23], v[24:27]
  s_mov_b32 s65, 166912
  buffer_load_dwordx4 a[124:127], v63, s[12:15], s65 offen nt
  v_and_b32_dpp v16, v50, v8 row_newbcast:1 row_mask:0xf bank_mask:0xf
  v_and_b32_dpp v17, v50, v9 row_newbcast:1 row_mask:0xf bank_mask:0xf
  v_and_b32_dpp v18, v50, v10 row_newbcast:1 row_mask:0xf bank_mask:0xf
  v_and_b32_dpp v19, v50, v11 row_newbcast:1 row_mask:0xf bank_mask:0xf
  s_waitcnt vmcnt(7)
  s_nop 0
  v_mfma_f32_16x16x32_bf16 v[24:27], a[96:99], v[16:19], v[24:27]
  s_mov_b32 s65, 167936
  buffer_load_dwordx4 a[128:131], v63, s[12:15], s65 offen nt
  v_and_b32_dpp v20, v50, v8 row_newbcast:5 row_mask:0xf bank_mask:0xf
  v_and_b32_dpp v21, v50, v9 row_newbcast:5 row_mask:0xf bank_mask:0xf
  v_and_b32_dpp v22, v50, v10 row_newbcast:5 row_mask:0xf bank_mask:0xf
  v_and_b32_dpp v23, v50, v11 row_newbcast:5 row_mask:0xf bank_mask:0xf
  s_waitcnt vmcnt(7)
  s_nop 0
  v_mfma_f32_16x16x32_bf16 v[24:27], a[100:103], v[20:23], v[24:27]
  s_mov_b32 s65, 168960
  buffer_load_dwordx4 a[132:135], v63, s[12:15], s65 offen nt
  v_and_b32_dpp v16, v50, v8 row_newbcast:9 row_mask:0xf bank_mask:0xf
  v_and_b32_dpp v17, v50, v9 row_newbcast:9 row_mask:0xf bank_mask:0xf
  v_and_b32_dpp v18, v50, v10 row_newbcast:9 row_mask:0xf bank_mask:0xf
  v_and_b32_dpp v19, v50, v11 row_newbcast:9 row_mask:0xf bank_mask:0xf
  s_waitcnt vmcnt(7)
  s_nop 0
  v_mfma_f32_16x16x32_bf16 v[24:27], a[104:107], v[16:19], v[24:27]
  s_mov_b32 s65, 169984
  buffer_load_dwordx4 a[136:139], v63, s[12:15], s65 offen nt
  v_and_b32_dpp v20, v50, v8 row_newbcast:13 row_mask:0xf bank_mask:0xf
  v_and_b32_dpp v21, v50, v9 row_newbcast:13 row_mask:0xf bank_mask:0xf
  v_and_b32_dpp v22, v50, v10 row_newbcast:13 row_mask:0xf bank_mask:0xf
  v_and_b32_dpp v23, v50, v11 row_newbcast:13 row_mask:0xf bank_mask:0xf
  s_waitcnt vmcnt(7)
  s_nop 0
  v_mfma_f32_16x16x32_bf16 v[24:27], a[108:111], v[20:23], v[24:27]
  s_mov_b32 s65, 171008
  buffer_load_dwordx4 a[140:143], v63, s[12:15], s65 offen nt
  v_and_b32_dpp v16, v50, v8 row_newbcast:2 row_mask:0xf bank_mask:0xf
  v_and_b32_dpp v17, v50, v9 row_newbcast:2 row_mask:0xf bank_mask:0xf
  v_and_b32_dpp v18, v50, v10 row_newbcast:2 row_mask:0xf bank_mask:0xf
  v_and_b32_dpp v19, v50, v11 row_newbcast:2 row_mask:0xf bank_mask:0xf
  s_waitcnt vmcnt(7)
  s_nop 0
  v_mfma_f32_16x16x32_bf16 v[24:27], a[112:115], v[16:19], v[24:27]
  s_mov_b32 s65, 196608
  buffer_load_dwordx4 a[144:147], v63, s[12:15], s65 offen nt
  v_and_b32_dpp v20, v50, v8 row_newbcast:6 row_mask:0xf bank_mask:0xf
  v_and_b32_dpp v21, v50, v9 row_newbcast:6 row_mask:0xf bank_mask:0xf
  v_and_b32_dpp v22, v50, v10 row_newbcast:6 row_mask:0xf bank_mask:0xf
  v_and_b32_dpp v23, v50, v11 row_newbcast:6 row_mask:0xf bank_mask:0xf
  s_waitcnt vmcnt(7)
  s_nop 0
  v_mfma_f32_16x16x32_bf16 v[24:27], a[116:119], v[20:23], v[24:27]
  s_mov_b32 s65, 197632
  buffer_load_dwordx4 a[148:151], v63, s[12:15], s65 offen nt
  v_and_b32_dpp v16, v50, v8 row_newbcast:10 row_mask:0xf bank_mask:0xf
  v_and_b32_dpp v17, v50, v9 row_newbcast:10 row_mask:0xf bank_mask:0xf
  v_and_b32_dpp v18, v50, v10 row_newbcast:10 row_mask:0xf bank_mask:0xf
  v_and_b32_dpp v19, v50, v11 row_newbcast:10 row_mask:0xf bank_mask:0xf
  s_waitcnt vmcnt(7)
  s_nop 0
  v_mfma_f32_16x16x32_bf16 v[24:27], a[120:123], v[16:19], v[24:27]
  s_mov_b32 s65, 198656
  buffer_load_dwordx4 a[152:155], v63, s[12:15], s65 offen nt
  v_and_b32_dpp v20, v50, v8 row_newbcast:14 row_mask:0xf bank_mask:0xf
  v_and_b32_dpp v21, v50, v9 row_newbcast:14 row_mask:0xf bank_mask:0xf
  v_and_b32_dpp v22, v50, v10 row_newbcast:14 row_mask:0xf bank_mask:0xf
  v_and_b32_dpp v23, v50, v11 row_newbcast:14 row_mask:0xf bank_mask:0xf
  s_waitcnt vmcnt(7)
  s_nop 0
  v_mfma_f32_16x16x32_bf16 v[24:27], a[124:127], v[20:23], v[24:27]
  s_mov_b32 s65, 199680
  buffer_load_dwordx4 a[156:159], v63, s[12:15], s65 offen nt
  v_and_b32_dpp v16, v50, v8 row_newbcast:3 row_mask:0xf bank_mask:0xf
  v_and_b32_dpp v17, v50, v9 row_newbcast:3 row_mask:0xf bank_mask:0xf
  v_and_b32_dpp v18, v50, v10 row_newbcast:3 row_mask:0xf bank_mask:0xf
  v_and_b32_dpp v19, v50, v11 row_newbcast:3 row_mask:0xf bank_mask:0xf
  s_waitcnt vmcnt(7)
  s_nop 0
  v_mfma_f32_16x16x32_bf16 v[24:27], a[128:131], v[16:19], v[24:27]
  s_mov_b32 s65, 200704
  buffer_load_dwordx4 a[160:163], v63, s[12:15], s65 offen nt
  v_and_b32_dpp v20, v50, v8 row_newbcast:7 row_mask:0xf bank_mask:0xf
  v_and_b32_dpp v21, v50, v9 row_newbcast:7 row_mask:0xf bank_mask:0xf
  v_and_b32_dpp v22, v50, v10 row_newbcast:7 row_mask:0xf bank_mask:0xf
  v_and_b32_dpp v23, v50, v11 row_newbcast:7 row_mask:0xf bank_mask:0xf
  s_waitcnt vmcnt(7)
  s_nop 0
  v_mfma_f32_16x16x32_bf16 v[24:27], a[132:135], v[20:23], v[24:27]
  s_mov_b32 s65, 201728
  buffer_load_dwordx4 a[164:167], v63, s[12:15], s65 offen nt
  v_and_b32_dpp v16, v50, v8 row_newbcast:11 row_mask:0xf bank_mask:0xf
  v_and_b32_dpp v17, v50, v9 row_newbcast:11 row_mask:0xf bank_mask:0xf
  v_and_b32_dpp v18, v50, v10 row_newbcast:11 row_mask:0xf bank_mask:0xf
  v_and_b32_dpp v19, v50, v11 row_newbcast:11 row_mask:0xf bank_mask:0xf
  s_waitcnt vmcnt(7)
  s_nop 0
  v_mfma_f32_16x16x32_bf16 v[24:27], a[136:139], v[16:19], v[24:27]
  s_mov_b32 s65, 202752
  buffer_load_dwordx4 a[168:171], v63, s[12:15], s65 offen nt
  v_and_b32_dpp v20, v50, v8 row_newbcast:15 row_mask:0xf bank_mask:0xf
  v_and_b32_dpp v21, v50, v9 row_newbcast:15 row_mask:0xf bank_mask:0xf
  v_and_b32_dpp v22, v50, v10 row_newbcast:15 row_mask:0xf bank_mask:0xf
  v_and_b32_dpp v23, v50, v11 row_newbcast:15 row_mask:0xf bank_mask:0xf
  s_waitcnt vmcnt(7)
  s_nop 0
  v_mfma_f32_16x16x32_bf16 v[24:27], a[140:143], v[20:23], v[24:27]
  s_mov_b32 s65, 203776
  buffer_load_dwordx4 a[172:175], v63, s[12:15], s65 offen nt
  v_and_b32_dpp v16, v51, v8 row_newbcast:0 row_mask:0xf bank_mask:0xf
  v_and_b32_dpp v17, v51, v9 row_newbcast:0 row_mask:0xf bank_mask:0xf
  v_and_b32_dpp v18, v51, v10 row_newbcast:0 row_mask:0xf bank_mask:0xf
  v_and_b32_dpp v19, v51, v11 row_newbcast:0 row_mask:0xf bank_mask:0xf
  s_waitcnt vmcnt(7)
  s_nop 0
  v_mfma_f32_16x16x32_bf16 v[24:27], a[144:147], v[16:19], v[24:27]
  s_mov_b32 s65, 229376
  buffer_load_dwordx4 a[176:179], v63, s[12:15], s65 offen nt
  v_and_b32_dpp v20, v51, v8 row_newbcast:4 row_mask:0xf bank_mask:0xf
  v_and_b32_dpp v21, v51, v9 row_newbcast:4 row_mask:0xf bank_mask:0xf
  v_and_b32_dpp v22, v51, v10 row_newbcast:4 row_mask:0xf bank_mask:0xf
  v_and_b32_dpp v23, v51, v11 row_newbcast:4 row_mask:0xf bank_mask:0xf
  s_waitcnt vmcnt(7)
  s_nop 0
  v_mfma_f32_16x16x32_bf16 v[24:27], a[148:151], v[20:23], v[24:27]
  s_mov_b32 s65, 230400
  buffer_load_dwordx4 a[180:183], v63, s[12:15], s65 offen nt
  v_and_b32_dpp v16, v51, v8 row_newbcast:8 row_mask:0xf bank_mask:0xf
  v_and_b32_dpp v17, v51, v9 row_newbcast:8 row_mask:0xf bank_mask:0xf
  v_and_b32_dpp v18, v51, v10 row_newbcast:8 row_mask:0xf bank_mask:0xf
  v_and_b32_dpp v19, v51, v11 row_newbcast:8 row_mask:0xf bank_mask:0xf
  s_waitcnt vmcnt(7)
  s_nop 0
  v_mfma_f32_16x16x32_bf16 v[24:27], a[152:155], v[16:19], v[24:27]
  s_mov_b32 s65, 231424
  buffer_load_dwordx4 a[184:187], v63, s[12:15], s65 offen nt
  v_and_b32_dpp v20, v51, v8 row_newbcast:12 row_mask:0xf bank_mask:0xf
  v_and_b32_dpp v21, v51, v9 row_newbcast:12 row_mask:0xf bank_mask:0xf
  v_and_b32_dpp v22, v51, v10 row_newbcast:12 row_mask:0xf bank_mask:0xf
  v_and_b32_dpp v23, v51, v11 row_newbcast:12 row_mask:0xf bank_mask:0xf
  s_waitcnt vmcnt(7)
  s_nop 0
  v_mfma_f32_16x16x32_bf16 v[24:27], a[156:159], v[20:23], v[24:27]
  s_mov_b32 s65, 232448
  buffer_load_dwordx4 a[188:191], v63, s[12:15], s65 offen nt
  v_and_b32_dpp v16, v51, v8 row_newbcast:1 row_mask:0xf bank_mask:0xf
  v_and_b32_dpp v17, v51, v9 row_newbcast:1 row_mask:0xf bank_mask:0xf
  v_and_b32_dpp v18, v51, v10 row_newbcast:1 row_mask:0xf bank_mask:0xf
  v_and_b32_dpp v19, v51, v11 row_newbcast:1 row_mask:0xf bank_mask:0xf
  s_waitcnt vmcnt(7)
  s_nop 0
  v_mfma_f32_16x16x32_bf16 v[24:27], a[160:163], v[16:19], v[24:27]
  s_mov_b32 s65, 233472
  buffer_load_dwordx4 a[192:195], v63, s[12:15], s65 offen nt
  v_and_b32_dpp v20, v51, v8 row_newbcast:5 row_mask:0xf bank_mask:0xf
  v_and_b32_dpp v21, v51, v9 row_newbcast:5 row_mask:0xf bank_mask:0xf
  v_and_b32_dpp v22, v51, v10 row_newbcast:5 row_mask:0xf bank_mask:0xf
  v_and_b32_dpp v23, v51, v11 row_newbcast:5 row_mask:0xf bank_mask:0xf
  s_waitcnt vmcnt(7)
  s_nop 0
  v_mfma_f32_16x16x32_bf16 v[24:27], a[164:167], v[20:23], v[24:27]
  s_mov_b32 s65, 234496
  buffer_load_dwordx4 a[196:199], v63, s[12:15], s65 offen nt
  v_and_b32_dpp v16, v51, v8 row_newbcast:9 row_mask:0xf bank_mask:0xf
  v_and_b32_dpp v17, v51, v9 row_newbcast:9 row_mask:0xf bank_mask:0xf
  v_and_b32_dpp v18, v51, v10 row_newbcast:9 row_mask:0xf bank_mask:0xf
  v_and_b32_dpp v19, v51, v11 row_newbcast:9 row_mask:0xf bank_mask:0xf
  s_waitcnt vmcnt(7)
  s_nop 0
  v_mfma_f32_16x16x32_bf16 v[24:27], a[168:171], v[16:19], v[24:27]
  s_mov_b32 s65, 235520
  buffer_load_dwordx4 a[200:203], v63, s[12:15], s65 offen nt
  v_and_b32_dpp v20, v51, v8 row_newbcast:13 row_mask:0xf bank_mask:0xf
  v_and_b32_dpp v21, v51, v9 row_newbcast:13 row_mask:0xf bank_mask:0xf
  v_and_b32_dpp v22, v51, v10 row_newbcast:13 row_mask:0xf bank_mask:0xf
  v_and_b32_dpp v23, v51, v11 row_newbcast:13 row_mask:0xf bank_mask:0xf
  s_waitcnt vmcnt(7)
  s_nop 0
  v_mfma_f32_16x16x32_bf16 v[24:27], a[172:175], v[20:23], v[24:27]
  s_mov_b32 s65, 236544
  buffer_load_dwordx4 a[204:207], v63, s[12:15], s65 offen nt
  v_and_b32_dpp v16, v51, v8 row_newbcast:2 row_mask:0xf bank_mask:0xf
  v_and_b32_dpp v17, v51, v9 row_newbcast:2 row_mask:0xf bank_mask:0xf
  v_and_b32_dpp v18, v51, v10 row_newbcast:2 row_mask:0xf bank_mask:0xf
  v_and_b32_dpp v19, v51, v11 row_newbcast:2 row_mask:0xf bank_mask:0xf
  s_waitcnt vmcnt(7)
  s_nop 0
  v_mfma_f32_16x16x32_bf16 v[24:27], a[176:179], v[16:19], v[24:27]
  v_and_b32_dpp v20, v51, v8 row_newbcast:6 row_mask:0xf bank_mask:0xf
  v_and_b32_dpp v21, v51, v9 row_newbcast:6 row_mask:0xf bank_mask:0xf
  v_and_b32_dpp v22, v51, v10 row_newbcast:6 row_mask:0xf bank_mask:0xf
  v_and_b32_dpp v23, v51, v11 row_newbcast:6 row_mask:0xf bank_mask:0xf
  s_waitcnt vmcnt(6)
  s_nop 0
  v_mfma_f32_16x16x32_bf16 v[24:27], a[180:183], v[20:23], v[24:27]
  v_and_b32_dpp v16, v51, v8 row_newbcast:10 row_mask:0xf bank_mask:0xf
  v_and_b32_dpp v17, v51, v9 row_newbcast:10 row_mask:0xf bank_mask:0xf
  v_and_b32_dpp v18, v51, v10 row_newbcast:10 row_mask:0xf bank_mask:0xf
  v_and_b32_dpp v19, v51, v11 row_newbcast:10 row_mask:0xf bank_mask:0xf
  s_waitcnt vmcnt(5)
  s_nop 0
  v_mfma_f32_16x16x32_bf16 v[24:27], a[184:187], v[16:19], v[24:27]
  v_and_b32_dpp v20, v51, v8 row_newbcast:14 row_mask:0xf bank_mask:0xf
  v_and_b32_dpp v21, v51, v9 row_newbcast:14 row_mask:0xf bank_mask:0xf
  v_and_b32_dpp v22, v51, v10 row_newbcast:14 row_mask:0xf bank_mask:0xf
  v_and_b32_dpp v23, v51, v11 row_newbcast:14 row_mask:0xf bank_mask:0xf
  s_waitcnt vmcnt(4)
  s_nop 0
  v_mfma_f32_16x16x32_bf16 v[24:27], a[188:191], v[20:23], v[24:27]
  v_and_b32_dpp v16, v51, v8 row_newbcast:3 row_mask:0xf bank_mask:0xf
  v_and_b32_dpp v17, v51, v9 row_newbcast:3 row_mask:0xf bank_mask:0xf
  v_and_b32_dpp v18, v51, v10 row_newbcast:3 row_mask:0xf bank_mask:0xf
  v_and_b32_dpp v19, v51, v11 row_newbcast:3 row_mask:0xf bank_mask:0xf
  s_waitcnt vmcnt(3)
  s_nop 0
  v_mfma_f32_16x16x32_bf16 v[24:27], a[192:195], v[16:19], v[24:27]
  v_and_b32_dpp v20, v51, v8 row_newbcast:7 row_mask:0xf bank_mask:0xf
  v_and_b32_dpp v21, v51, v9 row_newbcast:7 row_mask:0xf bank_mask:0xf
  v_and_b32_dpp v22, v51, v10 row_newbcast:7 row_mask:0xf bank_mask:0xf
  v_and_b32_dpp v23, v51, v11 row_newbcast:7 row_mask:0xf bank_mask:0xf
  s_waitcnt vmcnt(2)
  s_nop 0
  v_mfma_f32_16x16x32_bf16 v[24:27], a[196:199], v[20:23], v[24:27]
  v_and_b32_dpp v16, v51, v8 row_newbcast:11 row_mask:0xf bank_mask:0xf
  v_and_b32_dpp v17, v51, v9 row_newbcast:11 row_mask:0xf bank_mask:0xf
  v_and_b32_dpp v18, v51, v10 row_newbcast:11 row_mask:0xf bank_mask:0xf
  v_and_b32_dpp v19, v51, v11 row_newbcast:11 row_mask:0xf bank_mask:0xf
  s_waitcnt vmcnt(1)
  s_nop 0
  v_mfma_f32_16x16x32_bf16 v[24:27], a[200:203], v[16:19], v[24:27]
  v_and_b32_dpp v20, v51, v8 row_newbcast:15 row_mask:0xf bank_mask:0xf
  v_and_b32_dpp v21, v51, v9 row_newbcast:15 row_mask:0xf bank_mask:0xf
  v_and_b32_dpp v22, v51, v10 row_newbcast:15 row_mask:0xf bank_mask:0xf
  v_and_b32_dpp v23, v51, v11 row_newbcast:15 row_mask:0xf bank_mask:0xf
  s_waitcnt vmcnt(0)
  s_nop 0
  v_mfma_f32_16x16x32_bf16 v[24:27], a[204:207], v[20:23], v[24:27]
L_finG:
  s_nop 7
  ds_write_b128 v3, v[24:27] offset:2304
  ds_read_b32 v95, v84
  s_waitcnt lgkmcnt(1)
  s_barrier
  ds_read2st64_b32 v[16:17], v84 offset0:9 offset1:13
  ds_read2st64_b32 v[18:19], v84 offset0:17 offset1:21
  ds_read_b32 v95, v84
  s_waitcnt lgkmcnt(1)
  v_pk_add_f32 v[16:17], v[16:17], v[18:19]
  v_add_f32 v16, v16, v17
  v_cvt_pk_bf16_f32 v6, v16, v16
  v_min_u32 v6, -2, v6
  buffer_store_dword v6, v14, s[28:31], s75 offen sc1
  v_lshrrev_b32 v6, 5, v0
  v_and_b32 v7, 31, v0
  v_mul_u32_u24 v93, 1280, v6
  v_lshl_add_u32 v93, v7, 2, v93
  buffer_load_dwordx4 v[32:35], v92, s[24:27], 0 offen
  buffer_load_dwordx4 v[36:39], v92, s[24:27], 0 offen offset:512
  buffer_load_dword v40, v93, s[24:27], 0 offen offset:1024
  buffer_load_dword v41, v93, s[24:27], 0 offen offset:1152
  v_lshl_add_u32 v84, v6, 6, v93
  v_add_u32 v84, 28928, v84
  v_lshlrev_b32 v3, 12, v6
  v_lshl_add_u32 v3, v7, 4, v3
  v_bfe_u32 v7, v0, 4, 2
  v_bfe_u32 v6, v0, 2, 2
  v_lshl_add_u32 v6, v7, 3, v6
  v_lshlrev_b32 v4, 7, v6
  v_bfe_u32 v6, v0, 3, 2
  v_xor_b32 v6, s3, v6
  v_lshl_add_u32 v4, v6, 5, v4
  v_and_b32 v6, 3, v0
  v_lshl_add_u32 v4, v6, 3, v4
  v_add_u32 v4, 38656, v4
  v_add_u32 v15, 40960, v4
  v_and_b32 v6, 7, v0
  v_mul_u32_u24 v5, 1344, v6
  v_bfe_u32 v6, v0, 3, 3
  v_lshl_add_u32 v5, v6, 4, v5
  v_bfe_u32 v6, v0, 3, 1
  v_mul_u32_u24 v62, 0xaaaa, v6
  v_add_u32 v62, 0x4444, v62
  v_mov_b32 v12, 0x05040100
  v_mov_b32 v7, 0x03020706
  v_cmp_eq_u32 vcc, 1, v6
  s_nop 1
  v_cndmask_b32 v12, v12, v7, vcc
  v_mov_b32 v2, 0xc0
  s_and_b32 s77, s71, 1
  s_lshl_b32 s76, s101, 10
  s_add_u32 s76, s76, 106496
  s_mov_b32 s79, 0
  s_lshl_b32 s75, s70, 2
  s_add_u32 s75, s75, s3
  s_lshl_b32 s75, s75, 7
  s_add_u32 s75, s75, 98304
  s_lshl_b32 s7, s70, 12
  s_add_u32 s7, s7, 163904
  v_mov_b32 v14, s7
  v_writelane_b32 v14, s75, 0
  s_mov_b32 s70, 0xbfb8aa3b
  s_mov_b32 s71, 0xbfb8aa3b
  s_mov_b32 s72, 0x00003f80
  s_mov_b32 s73, 0x3f800000
  s_mov_b32 s66, 1
  s_cmp_lg_u32 s66, 0
  s_branch L_Grow
L_Gwait:
L_Gtrig:
  buffer_load_dword v7, v14, s[28:31], 0 offen sc1
  s_add_u32 s100, s100, 1
  s_cmp_gt_u32 s100, 200000
  s_cbranch_scc1 L_end
  s_waitcnt vmcnt(0)
  v_cmp_ne_u32 vcc, 0, v7
  s_cbranch_vccz L_Gtrig
  s_mov_b32 m0, s40
  s_mov_b32 s65, 0
  buffer_load_dwordx4 v91, s[20:23], s65 offen nt lds
  s_mov_b32 m0, s41
  s_mov_b32 s65, 110592
  buffer_load_dwordx4 v91, s[20:23], s65 offen nt lds
  s_mov_b32 m0, s42
  s_mov_b32 s65, 221184
  buffer_load_dwordx4 v91, s[20:23], s65 offen nt lds
  s_mov_b32 m0, s43
  s_mov_b32 s65, 331776
  buffer_load_dwordx4 v91, s[20:23], s65 offen nt lds
  s_mov_b32 m0, s44
  s_mov_b32 s65, 442368
  buffer_load_dwordx4 v91, s[20:23], s65 offen nt lds
  s_mov_b32 m0, s45
  s_mov_b32 s65, 552960
  buffer_load_dwordx4 v91, s[20:23], s65 offen nt lds
  s_mov_b32 m0, s46
  s_mov_b32 s65, 663552
  buffer_load_dwordx4 v91, s[20:23], s65 offen nt lds
  s_mov_b32 m0, s47
  s_mov_b32 s65, 774144
  buffer_load_dwordx4 v91, s[20:23], s65 offen nt lds
  s_mov_b32 m0, s48
  s_mov_b32 s65, 884736
  buffer_load_dwordx4 v91, s[20:23], s65 offen nt lds
  s_mov_b32 m0, s49
  s_mov_b32 s65, 995328
  buffer_load_dwordx4 v91, s[20:23], s65 offen nt lds
  s_mov_b32 m0, s50
  s_mov_b32 s65, 1105920
  buffer_load_dwordx4 v91, s[20:23], s65 offen nt lds
  s_mov_b32 m0, s51
  s_mov_b32 s65, 1216512
  buffer_load_dwordx4 v91, s[20:23], s65 offen nt lds
  s_mov_b32 m0, s52
  s_mov_b32 s65, 1327104
  buffer_load_dwordx4 v91, s[20:23], s65 offen nt lds
  s_mov_b32 m0, s53
  s_mov_b32 s65, 1437696
  buffer_load_dwordx4 v91, s[20:23], s65 offen nt lds
  s_mov_b32 m0, s54
  s_mov_b32 s65, 1548288
  buffer_load_dwordx4 v91, s[20:23], s65 offen nt lds
  s_mov_b32 m0, s55
  s_mov_b32 s65, 1658880
  buffer_load_dwordx4 v91, s[20:23], s65 offen nt lds
  s_mov_b32 m0, s56
  s_mov_b32 s65, 1769472
  buffer_load_dwordx4 v91, s[20:23], s65 offen nt lds
  s_mov_b32 m0, s57
  s_mov_b32 s65, 1880064
  buffer_load_dwordx4 v91, s[20:23], s65 offen nt lds
  s_mov_b32 m0, s58
  s_mov_b32 s65, 1990656
  buffer_load_dwordx4 v91, s[20:23], s65 offen nt lds
  s_mov_b32 m0, s59
  s_mov_b32 s65, 2101248
  buffer_load_dwordx4 v91, s[20:23], s65 offen nt lds
  s_mov_b32 s66, 0
  s_waitcnt vmcnt(0)
  s_barrier
  ds_read_b64_tr_b16 v[96:97], v4 offset:0
  ds_read_b64_tr_b16 v[98:99], v4 offset:512
  ds_read_b64_tr_b16 v[100:101], v4 offset:4096
  ds_read_b64_tr_b16 v[102:103], v4 offset:4608
  ds_read_b64_tr_b16 v[104:105], v4 offset:8192
  ds_read_b64_tr_b16 v[106:107], v4 offset:8704
  ds_read_b64_tr_b16 v[108:109], v4 offset:12288
  ds_read_b64_tr_b16 v[110:111], v4 offset:12800
  s_waitcnt lgkmcnt(4)
  ds_read_b64_tr_b16 v[112:113], v4 offset:16384
  ds_read_b64_tr_b16 v[114:115], v4 offset:16896
  ds_read_b64_tr_b16 v[116:117], v4 offset:20480
  ds_read_b64_tr_b16 v[118:119], v4 offset:20992
  ds_read_b64_tr_b16 v[120:121], v4 offset:24576
  ds_read_b64_tr_b16 v[122:123], v4 offset:25088
  ds_read_b64_tr_b16 v[124:125], v4 offset:28672
  ds_read_b64_tr_b16 v[126:127], v4 offset:29184
  s_waitcnt lgkmcnt(4)
  ds_read_b64_tr_b16 v[128:129], v4 offset:32768
  ds_read_b64_tr_b16 v[130:131], v4 offset:33280
  ds_read_b64_tr_b16 v[132:133], v4 offset:36864
  ds_read_b64_tr_b16 v[134:135], v4 offset:37376
  ds_read_b64_tr_b16 v[136:137], v15 offset:0
  ds_read_b64_tr_b16 v[138:139], v15 offset:512
  ds_read_b64_tr_b16 v[140:141], v15 offset:4096
  ds_read_b64_tr_b16 v[142:143], v15 offset:4608
  s_waitcnt lgkmcnt(4)
  ds_read_b64_tr_b16 v[144:145], v15 offset:8192
  ds_read_b64_tr_b16 v[146:147], v15 offset:8704
  ds_read_b64_tr_b16 v[148:149], v15 offset:12288
  ds_read_b64_tr_b16 v[150:151], v15 offset:12800
  ds_read_b64_tr_b16 v[152:153], v15 offset:16384
  ds_read_b64_tr_b16 v[154:155], v15 offset:16896
  ds_read_b64_tr_b16 v[156:157], v15 offset:20480
  ds_read_b64_tr_b16 v[158:159], v15 offset:20992
  s_waitcnt lgkmcnt(4)
  ds_read_b64_tr_b16 v[160:161], v15 offset:24576
  ds_read_b64_tr_b16 v[162:163], v15 offset:25088
  ds_read_b64_tr_b16 v[164:165], v15 offset:28672
  ds_read_b64_tr_b16 v[166:167], v15 offset:29184
  ds_read_b64_tr_b16 v[168:169], v15 offset:32768
  ds_read_b64_tr_b16 v[170:171], v15 offset:33280
  ds_read_b64_tr_b16 v[172:173], v15 offset:36864
  ds_read_b64_tr_b16 v[174:175], v15 offset:37376
  s_waitcnt lgkmcnt(4)
  v_lshlrev_b32 v208, 16, v32
  v_and_b32 v209, 0xffff0000, v32
  v_lshlrev_b32 v210, 16, v33
  v_and_b32 v211, 0xffff0000, v33
  v_lshlrev_b32 v212, 16, v34
  v_and_b32 v213, 0xffff0000, v34
  v_lshlrev_b32 v214, 16, v35
  v_and_b32 v215, 0xffff0000, v35
  v_lshlrev_b32 v216, 16, v40
  v_and_b32 v217, 0xffff0000, v40
  v_lshlrev_b32 v218, 16, v36
  v_and_b32 v219, 0xffff0000, v36
  v_lshlrev_b32 v220, 16, v37
  v_and_b32 v221, 0xffff0000, v37
  v_lshlrev_b32 v222, 16, v38
  v_and_b32 v223, 0xffff0000, v38
  v_lshlrev_b32 v224, 16, v39
  v_and_b32 v225, 0xffff0000, v39
  v_lshlrev_b32 v226, 16, v41
  v_and_b32 v227, 0xffff0000, v41
L_Gpoll:
  buffer_load_dword v7, off, s[28:31], s75 sc1
  s_add_u32 s100, s100, 1
  s_cmp_gt_u32 s100, 200000
  s_cbranch_scc1 L_end
  s_waitcnt vmcnt(0)
  v_cmp_ne_u32 vcc, 0x101, v7
  s_cbranch_vccnz L_Gpoll
L_Gseen:
L_Gread:
  buffer_load_dwordx4 v[176:179], v3, s[28:31], 0 offen offset:0 sc1
  buffer_load_dwordx4 v[180:183], v3, s[28:31], 0 offen offset:1024 sc1
  buffer_load_dwordx4 v[184:187], v3, s[28:31], 0 offen offset:2048 sc1
  buffer_load_dwordx4 v[188:191], v3, s[28:31], 0 offen offset:3072 sc1
  buffer_load_dwordx4 v[192:195], v3, s[28:31], 0 offen offset:512 sc1
  buffer_load_dwordx4 v[196:199], v3, s[28:31], 0 offen offset:1536 sc1
  buffer_load_dwordx4 v[200:203], v3, s[28:31], 0 offen offset:2560 sc1
  buffer_load_dwordx4 v[204:207], v3, s[28:31], 0 offen offset:3584 sc1
L_Gld:
  s_add_u32 s100, s100, 1
  s_cmp_gt_u32 s100, 200000
  s_cbranch_scc1 L_end
  s_waitcnt vmcnt(4)
  s_cmp_lg_u32 s66, 0
L_Grow:
  v_cvt_pk_bf16_f32 v64, v176, v177
  v_cvt_pk_bf16_f32 v65, v178, v180
  v_cvt_pk_bf16_f32 v66, v181, v182
  v_cvt_pk_bf16_f32 v67, v184, v185
  v_cvt_pk_bf16_f32 v68, v188, v189
  v_dot2_f32_bf16 v228, v64, s72, v208
  v_dot2_f32_bf16 v229, v64, s73, v209
  v_dot2_f32_bf16 v230, v65, s72, v210
  v_dot2_f32_bf16 v231, v65, s73, v211
  v_dot2_f32_bf16 v232, v66, s72, v212
  v_dot2_f32_bf16 v233, v66, s73, v213
  v_dot2_f32_bf16 v234, v67, s72, v214
  v_dot2_f32_bf16 v235, v67, s73, v215
  v_dot2_f32_bf16 v236, v68, s72, v216
  v_dot2_f32_bf16 v237, v68, s73, v217
  v_min3_f32 v6, v179, v183, v187
  v_cvt_pk_bf16_f32 v64, v228, v229
  v_cvt_pk_bf16_f32 v65, v230, v231
  v_cvt_pk_bf16_f32 v66, v232, v233
  v_cvt_pk_bf16_f32 v67, v234, v235
  v_cvt_pk_bf16_f32 v68, v236, v237
  v_lshlrev_b32 v7, 16, v64
  v_xor_b32 v7, 0x80000000, v7
  s_cbranch_scc1 L_Gnw
  s_waitcnt vmcnt(0)
L_Gnw:
  v_min3_f32 v6, v6, v191, v195
  v_mov_b32_dpp v56, v7 row_newbcast:0 row_mask:0xf bank_mask:0xf
  v_min3_f32 v6, v6, v199, v203
  v_min_f32 v6, v6, v207
  v_mov_b32_dpp v56, v56 row_bcast:15 row_mask:0xa bank_mask:0xf
  v_cmp_neq_f32 vcc, 0x42000000, v6
  v_cvt_pk_bf16_f32 v69, v192, v193
  v_cvt_pk_bf16_f32 v70, v194, v196
  v_cvt_pk_bf16_f32 v71, v197, v198
  v_cvt_pk_bf16_f32 v72, v200, v201
  v_cvt_pk_bf16_f32 v73, v204, v205
  s_cbranch_scc1 L_Gok
  s_cbranch_vccnz L_Gread
L_Gok:
  v_dot2_f32_bf16 v238, v69, s72, v218
  v_dot2_f32_bf16 v239, v69, s73, v219
  v_dot2_f32_bf16 v240, v70, s72, v220
  v_dot2_f32_bf16 v241, v70, s73, v221
  v_dot2_f32_bf16 v242, v71, s72, v222
  v_dot2_f32_bf16 v243, v71, s73, v223
  v_dot2_f32_bf16 v244, v72, s72, v224
  v_dot2_f32_bf16 v245, v72, s73, v225
  v_dot2_f32_bf16 v246, v73, s72, v226
  v_dot2_f32_bf16 v247, v73, s73, v227
  v_dot2_f32_bf16 v228, v64, s72, v56
  v_dot2_f32_bf16 v229, v64, s73, v56
  v_dot2_f32_bf16 v230, v65, s72, v56
  v_dot2_f32_bf16 v231, v65, s73, v56
  v_dot2_f32_bf16 v232, v66, s72, v56
  v_dot2_f32_bf16 v233, v66, s73, v56
  v_dot2_f32_bf16 v234, v67, s72, v56
  v_dot2_f32_bf16 v235, v67, s73, v56
  v_dot2_f32_bf16 v236, v68, s72, v56
  v_dot2_f32_bf16 v237, v68, s73, v56
  v_cvt_pk_bf16_f32 v69, v238, v239
  v_cvt_pk_bf16_f32 v70, v240, v241
  v_cvt_pk_bf16_f32 v71, v242, v243
  v_cvt_pk_bf16_f32 v72, v244, v245
  v_cvt_pk_bf16_f32 v73, v246, v247
  v_dot2_f32_bf16 v238, v69, s72, v56
  v_dot2_f32_bf16 v239, v69, s73, v56
  v_dot2_f32_bf16 v240, v70, s72, v56
  v_dot2_f32_bf16 v241, v70, s73, v56
  v_dot2_f32_bf16 v242, v71, s72, v56
  v_dot2_f32_bf16 v243, v71, s73, v56
  v_dot2_f32_bf16 v244, v72, s72, v56
  v_dot2_f32_bf16 v245, v72, s73, v56
  v_dot2_f32_bf16 v246, v73, s72, v56
  v_dot2_f32_bf16 v247, v73, s73, v56
  v_pk_mul_f32 v[54:55], v[228:229], v[228:229]
  v_pk_fma_f32 v[54:55], v[230:231], v[230:231], v[54:55]
  v_pk_add_f32 v[52:53], v[228:229], v[230:231]
  v_pk_fma_f32 v[54:55], v[232:233], v[232:233], v[54:55]
  v_pk_add_f32 v[52:53], v[52:53], v[232:233]
  v_pk_fma_f32 v[54:55], v[234:235], v[234:235], v[54:55]
  v_pk_add_f32 v[52:53], v[52:53], v[234:235]
  v_pk_fma_f32 v[54:55], v[236:237], v[236:237], v[54:55]
  v_pk_add_f32 v[52:53], v[52:53], v[236:237]
  v_pk_fma_f32 v[54:55], v[238:239], v[238:239], v[54:55]
  v_pk_add_f32 v[52:53], v[52:53], v[238:239]
  v_pk_fma_f32 v[54:55], v[240:241], v[240:241], v[54:55]
  v_pk_add_f32 v[52:53], v[52:53], v[240:241]
  v_pk_fma_f32 v[54:55], v[242:243], v[242:243], v[54:55]
  v_pk_add_f32 v[52:53], v[52:53], v[242:243]
  v_pk_fma_f32 v[54:55], v[244:245], v[244:245], v[54:55]
  v_pk_add_f32 v[52:53], v[52:53], v[244:245]
  v_pk_fma_f32 v[54:55], v[246:247], v[246:247], v[54:55]
  v_pk_add_f32 v[52:53], v[52:53], v[246:247]
  v_add_f32 v54, v54, v55
  v_add_f32 v52, v52, v53
  s_nop 0
  v_add_f32_dpp v54, v54, v54 quad_perm:[1,0,3,2] row_mask:0xf bank_mask:0xf
  v_add_f32_dpp v52, v52, v52 quad_perm:[1,0,3,2] row_mask:0xf bank_mask:0xf
  s_nop 0
  v_add_f32_dpp v54, v54, v54 quad_perm:[2,3,0,1] row_mask:0xf bank_mask:0xf
  v_add_f32_dpp v52, v52, v52 quad_perm:[2,3,0,1] row_mask:0xf bank_mask:0xf
  s_nop 0
  v_add_f32_dpp v54, v54, v54 row_half_mirror row_mask:0xf bank_mask:0xf
  v_add_f32_dpp v52, v52, v52 row_half_mirror row_mask:0xf bank_mask:0xf
  s_nop 0
  v_add_f32_dpp v54, v54, v54 row_mirror row_mask:0xf bank_mask:0xf
  v_add_f32_dpp v52, v52, v52 row_mirror row_mask:0xf bank_mask:0xf
  v_mov_b32 v53, v52
  v_mov_b32 v55, v54
  s_nop 0
  v_permlane16_swap_b32 v52, v53
  v_permlane16_swap_b32 v54, v55
  v_add_f32 v52, v52, v53
  v_add_f32 v54, v54, v55
  v_mul_f32 v52, 0x3acccccd, v52
  v_mul_f32 v54, 0x3acccccd, v54
  v_sub_f32 v53, v52, v56
  v_fma_f32 v54, -v52, v52, v54
  v_cvt_pk_bf16_f32 v52, 0, v53
  v_cvt_pk_bf16_f32 v54, 0, v54
  v_add_f32 v58, v52, v56
  v_max_f32 v54, 0, v54
  v_add_f32 v54, 0x3727c5ac, v54
  v_cvt_pk_bf16_f32 v54, 0, v54
  v_sqrt_f32 v54, v54
  v_pk_add_f32 v[228:229], v[228:229], v[58:59] op_sel_hi:[1,0] neg_lo:[0,1] neg_hi:[0,1]
  v_cvt_pk_bf16_f32 v228, 0, v228
  v_cvt_pk_bf16_f32 v229, 0, v229
  v_cvt_pk_bf16_f32 v54, 0, v54
  v_rcp_f32 v54, v54
  v_pk_add_f32 v[230:231], v[230:231], v[58:59] op_sel_hi:[1,0] neg_lo:[0,1] neg_hi:[0,1]
  v_cvt_pk_bf16_f32 v230, 0, v230
  v_cvt_pk_bf16_f32 v231, 0, v231
  v_pk_add_f32 v[232:233], v[232:233], v[58:59] op_sel_hi:[1,0] neg_lo:[0,1] neg_hi:[0,1]
  v_cvt_pk_bf16_f32 v232, 0, v232
  v_cvt_pk_bf16_f32 v233, 0, v233
  v_pk_add_f32 v[234:235], v[234:235], v[58:59] op_sel_hi:[1,0] neg_lo:[0,1] neg_hi:[0,1]
  v_cvt_pk_bf16_f32 v234, 0, v234
  v_cvt_pk_bf16_f32 v235, 0, v235
  v_pk_mul_f32 v[228:229], v[228:229], v[54:55] op_sel_hi:[1,0]
  v_cvt_pk_bf16_f32 v176, v228, v229
  v_pk_mul_f32 v[230:231], v[230:231], v[54:55] op_sel_hi:[1,0]
  v_cvt_pk_bf16_f32 v177, v230, v231
  v_pk_mul_f32 v[232:233], v[232:233], v[54:55] op_sel_hi:[1,0]
  v_cvt_pk_bf16_f32 v178, v232, v233
  v_pk_mul_f32 v[234:235], v[234:235], v[54:55] op_sel_hi:[1,0]
  v_cvt_pk_bf16_f32 v179, v234, v235
  ds_write_b128 v13, v[176:179] offset:27904
  v_pk_add_f32 v[238:239], v[238:239], v[58:59] op_sel_hi:[1,0] neg_lo:[0,1] neg_hi:[0,1]
  v_cvt_pk_bf16_f32 v238, 0, v238
  v_cvt_pk_bf16_f32 v239, 0, v239
  v_pk_mul_f32 v[238:239], v[238:239], v[54:55] op_sel_hi:[1,0]
  v_cvt_pk_bf16_f32 v180, v238, v239
  v_pk_add_f32 v[240:241], v[240:241], v[58:59] op_sel_hi:[1,0] neg_lo:[0,1] neg_hi:[0,1]
  v_cvt_pk_bf16_f32 v240, 0, v240
  v_cvt_pk_bf16_f32 v241, 0, v241
  v_pk_mul_f32 v[240:241], v[240:241], v[54:55] op_sel_hi:[1,0]
  v_cvt_pk_bf16_f32 v181, v240, v241
  v_pk_add_f32 v[242:243], v[242:243], v[58:59] op_sel_hi:[1,0] neg_lo:[0,1] neg_hi:[0,1]
  v_cvt_pk_bf16_f32 v242, 0, v242
  v_cvt_pk_bf16_f32 v243, 0, v243
  v_pk_mul_f32 v[242:243], v[242:243], v[54:55] op_sel_hi:[1,0]
  v_cvt_pk_bf16_f32 v182, v242, v243
  v_pk_add_f32 v[244:245], v[244:245], v[58:59] op_sel_hi:[1,0] neg_lo:[0,1] neg_hi:[0,1]
  v_cvt_pk_bf16_f32 v244, 0, v244
  v_cvt_pk_bf16_f32 v245, 0, v245
  v_pk_mul_f32 v[244:245], v[244:245], v[54:55] op_sel_hi:[1,0]
  v_cvt_pk_bf16_f32 v183, v244, v245
  ds_write_b128 v13, v[180:183] offset:28416
  v_pk_add_f32 v[236:237], v[236:237], v[58:59] op_sel_hi:[1,0] neg_lo:[0,1] neg_hi:[0,1]
  v_cvt_pk_bf16_f32 v236, 0, v236
  v_cvt_pk_bf16_f32 v237, 0, v237
  v_pk_mul_f32 v[236:237], v[236:237], v[54:55] op_sel_hi:[1,0]
  v_cvt_pk_bf16_f32 v184, v236, v237
  v_pk_add_f32 v[246:247], v[246:247], v[58:59] op_sel_hi:[1,0] neg_lo:[0,1] neg_hi:[0,1]
  v_cvt_pk_bf16_f32 v246, 0, v246
  v_cvt_pk_bf16_f32 v247, 0, v247
  v_pk_mul_f32 v[246:247], v[246:247], v[54:55] op_sel_hi:[1,0]
  v_cvt_pk_bf16_f32 v185, v246, v247
  ds_write2_b32 v84, v184, v185 offset0:0 offset1:32
  v_mov_b32 v24, 0
  v_mov_b32 v25, 0
  v_mov_b32 v26, 0
  v_mov_b32 v27, 0
  s_waitcnt lgkmcnt(0)
  s_barrier
  ds_read_b128 v[188:191], v5 offset:27904
  ds_read_b128 v[192:195], v5 offset:28032
  ds_read_b128 v[196:199], v5 offset:28160
  ds_read_b128 v[200:203], v5 offset:28288
  ds_read_b128 v[204:207], v5 offset:28416
  ds_read_b128 v[208:211], v5 offset:28544
  ds_read_b128 v[212:215], v5 offset:28672
  ds_read_b128 v[216:219], v5 offset:28800
  ds_read_b128 v[220:223], v5 offset:28928
  ds_read_b128 v[224:227], v5 offset:29056
  global_load_dword v95, v2, s[60:61] sc1
  s_waitcnt lgkmcnt(9)
  v_smfmac_f32_16x16x64_bf16 v[24:27], v[188:191], v[96:103], v62
  s_waitcnt lgkmcnt(8)
  v_smfmac_f32_16x16x64_bf16 v[24:27], v[192:195], v[104:111], v62
  s_waitcnt lgkmcnt(7)
  v_smfmac_f32_16x16x64_bf16 v[24:27], v[196:199], v[112:119], v62
  s_waitcnt lgkmcnt(6)
  v_smfmac_f32_16x16x64_bf16 v[24:27], v[200:203], v[120:127], v62
  s_waitcnt lgkmcnt(5)
  v_smfmac_f32_16x16x64_bf16 v[24:27], v[204:207], v[128:135], v62
  s_waitcnt lgkmcnt(4)
  v_smfmac_f32_16x16x64_bf16 v[24:27], v[208:211], v[136:143], v62
  s_waitcnt lgkmcnt(3)
  v_smfmac_f32_16x16x64_bf16 v[24:27], v[212:215], v[144:151], v62
  s_waitcnt lgkmcnt(2)
  v_smfmac_f32_16x16x64_bf16 v[24:27], v[216:219], v[152:159], v62
  s_waitcnt lgkmcnt(1)
  v_smfmac_f32_16x16x64_bf16 v[24:27], v[220:223], v[160:167], v62
  s_waitcnt lgkmcnt(0)
  v_smfmac_f32_16x16x64_bf16 v[24:27], v[224:227], v[168:175], v62
  s_cmp_eq_u32 s77, 0
  s_nop 6
  v_permlane32_swap_b32 v24, v26
  v_permlane32_swap_b32 v25, v27
  s_nop 0
  v_pk_add_f32 v[16:17], v[24:25], v[26:27]
  s_cbranch_scc0 L_Gup
  v_cvt_pk_bf16_f32 v16, 0, v16
  v_cvt_pk_bf16_f32 v17, 0, v17
  v_pk_mul_f32 v[16:17], v[16:17], s[70:71]
  v_exp_f32 v16, v16
  v_exp_f32 v17, v17
  v_add_f32 v16, 1.0, v16
  v_add_f32 v17, 1.0, v17
  v_rcp_f32 v16, v16
  v_rcp_f32 v17, v17
  s_nop 0
L_Gup:
  v_cvt_pk_bf16_f32 v6, v16, v17
  s_cmp_eq_u32 s66, 0
  s_waitcnt vmcnt(0)
  v_mov_b32_dpp v7, v6 row_ror:8 row_mask:0xf bank_mask:0xf
  v_cmp_ne_u32 vcc, 0, v95
  v_perm_b32 v6, v7, v6, v12
  v_min_u32 v6, -2, v6
  s_cbranch_scc0 L_Gwait
  s_cbranch_vccnz L_Gfar
  buffer_store_dword v6, v89, s[28:31], s76 offen
L_Gdone:
L_end:
  s_endpgm
L_lslow:
  s_cmp_lg_u32 s79, 0
  s_cbranch_scc1 L_lseen
  s_add_u32 s100, s100, 1
  s_cmp_gt_u32 s100, 200000
  s_cbranch_scc1 L_end
  v_mov_b32 v54, s78
  global_load_dword v54, v54, s[60:61] sc1
  s_waitcnt vmcnt(0)
  v_readfirstlane_b32 s79, v54
  s_nop 3
  s_branch L_lslow
L_lseen:
  s_cmp_eq_u32 s79, s77
  s_cbranch_scc1 L_lok
  s_mov_b32 s79, 1
  s_atomic_or s79, s[60:61], 0xc0 glc
  s_mov_b32 s64, 1
  buffer_store_dwordx4 v[208:211], v74, s[28:31], s67 offen sc1
  s_waitcnt vmcnt(0) lgkmcnt(0)
  s_barrier
  s_cmp_eq_u32 s3, 0
  s_cbranch_scc0 L_noqf
  s_mov_b64 exec, 1
  buffer_store_dword v53, off, s[28:31], s74 sc1
  s_mov_b64 exec, -1
  s_branch L_noqf
L_qslow:
  s_cmp_lg_u32 s64, 0
  s_cbranch_scc1 L_qok
  s_add_u32 s100, s100, 1
  s_cmp_gt_u32 s100, 200000
  s_cbranch_scc1 L_end
  buffer_load_dword v54, v52, s[28:31], s75 offen sc1
  s_waitcnt vmcnt(0)
  v_cmp_eq_u32 vcc, 0, v54
  s_cbranch_vccnz L_qslow
  s_branch L_qok
L_qlocal:
  s_and_b32 s7, s5, 7
  s_mul_i32 s7, s7, 655360
  s_sub_u32 s32, s16, s7
  s_subb_u32 s33, s17, 0
  s_add_u32 s34, s18, s7
  s_mov_b32 s35, 0x20000
  s_mul_i32 s7, s3, 160
  v_add_u32 v56, s7, v7
  v_and_b32 v57, 15, v0
  v_lshlrev_b32 v57, 4, v57
  v_lshl_add_u32 v57, v56, 13, v57
  s_mul_i32 s7, s5, 1344
  v_lshl_add_u32 v56, v56, 1, s7
  v_and_b32 v54, 7, v0
  v_lshl_add_u32 v54, v7, 5, v54
  s_lshl_b32 s7, s3, 9
  v_lshl_add_u32 v54, v54, 2, s7
  v_mov_b32 v64, 0
  v_mov_b32 v65, 0
  v_mov_b32 v66, 0
  v_mov_b32 v67, 0
  s_mov_b32 s7, 0
L_qloop:
  buffer_load_dwordx4 v[68:71], v57, s[32:35], s7 offen
  ds_read_u16 v58, v56 offset:27904
  s_add_u32 s7, s7, 32768
  s_waitcnt lgkmcnt(0)
  v_add_u32 v56, 8, v56
  v_lshl_or_b32 v58, v58, 16, v58
  v_and_b32 v16, v58, v8
  v_and_b32 v17, v58, v9
  v_and_b32 v18, v58, v10
  v_and_b32 v19, v58, v11
  s_cmp_lt_u32 s7, 1310720
  s_waitcnt vmcnt(0)
  v_mfma_f32_16x16x32_bf16 v[64:67], v[68:71], v[16:19], v[64:67]
  s_cbranch_scc1 L_qloop
  s_nop 7
  ds_write_b32 v54, v66 offset:64
  ds_write_b32 v54, v67 offset:96
  s_branch L_qjoin
L_islow:
  s_add_u32 s100, s100, 1
  s_cmp_gt_u32 s100, 200000
  s_cbranch_scc1 L_end
  v_mov_b32 v52, 0x80
  global_load_dwordx2 v[52:53], v52, s[60:61] sc1
  s_waitcnt vmcnt(0)
  v_readfirstlane_b32 s34, v52
  v_readfirstlane_b32 s35, v53
  s_nop 3
  s_branch L_ichk
L_Dhslow:
  s_add_u32 s100, s100, 1
  s_cmp_gt_u32 s100, 200000
  s_cbranch_scc1 L_end
  buffer_load_dwordx4 v[184:187], v12, s[28:31], 0 offen sc1
  s_waitcnt vmcnt(0)
  s_branch L_Dhc
L_lslowG:
  s_cmp_lg_u32 s79, 0
  s_cbranch_scc1 L_lseenG
  s_add_u32 s100, s100, 1
  s_cmp_gt_u32 s100, 200000
  s_cbranch_scc1 L_end
  v_mov_b32 v54, s78
  global_load_dword v54, v54, s[60:61] sc1
  s_waitcnt vmcnt(0)
  v_readfirstlane_b32 s79, v54
  s_nop 3
  s_branch L_lslowG
L_lseenG:
  s_cmp_eq_u32 s79, s77
  s_cbranch_scc1 L_lokG
  s_mov_b32 s79, 1
  s_atomic_or s79, s[60:61], 0xc0 glc
  s_mov_b32 s64, 1
  buffer_store_dwordx4 v[208:211], v74, s[28:31], s67 offen sc1
  s_waitcnt vmcnt(0) lgkmcnt(0)
  s_barrier
  s_cmp_eq_u32 s3, 0
  s_cbranch_scc0 L_noqfG
  s_mov_b64 exec, 1
  buffer_store_dword v53, off, s[28:31], s74 sc1
  s_mov_b64 exec, -1
  s_branch L_noqfG
L_qslowG:
  s_cmp_lg_u32 s64, 0
  s_cbranch_scc1 L_qokG
  s_add_u32 s100, s100, 1
  s_cmp_gt_u32 s100, 200000
  s_cbranch_scc1 L_end
  buffer_load_dword v54, v52, s[28:31], s75 offen sc1
  s_waitcnt vmcnt(0)
  v_cmp_eq_u32 vcc, 0, v54
  s_cbranch_vccnz L_qslowG
  s_branch L_qokG
L_qlocalG:
  s_and_b32 s7, s5, 7
  s_mul_i32 s7, s7, 655360
  s_sub_u32 s32, s16, s7
  s_subb_u32 s33, s17, 0
  s_add_u32 s34, s18, s7
  s_mov_b32 s35, 0x20000
  s_mul_i32 s7, s3, 160
  v_add_u32 v56, s7, v7
  v_and_b32 v57, 15, v0
  v_lshlrev_b32 v57, 4, v57
  v_lshl_add_u32 v57, v56, 13, v57
  s_mul_i32 s7, s5, 1344
  v_lshl_add_u32 v56, v56, 1, s7
  v_and_b32 v54, 7, v0
  v_lshl_add_u32 v54, v7, 5, v54
  s_lshl_b32 s7, s3, 9
  v_lshl_add_u32 v54, v54, 2, s7
  v_mov_b32 v64, 0
  v_mov_b32 v65, 0
  v_mov_b32 v66, 0
  v_mov_b32 v67, 0
  s_mov_b32 s7, 0
L_qloopG:
  buffer_load_dwordx4 v[68:71], v57, s[32:35], s7 offen
  ds_read_u16 v58, v56 offset:27904
  s_add_u32 s7, s7, 32768
  s_waitcnt lgkmcnt(0)
  v_add_u32 v56, 8, v56
  v_lshl_or_b32 v58, v58, 16, v58
  v_and_b32 v16, v58, v8
  v_and_b32 v17, v58, v9
  v_and_b32 v18, v58, v10
  v_and_b32 v19, v58, v11
  s_cmp_lt_u32 s7, 1310720
  s_waitcnt vmcnt(0)
  v_mfma_f32_16x16x32_bf16 v[64:67], v[68:71], v[16:19], v[64:67]
  s_cbranch_scc1 L_qloopG
  s_nop 7
  ds_write_b32 v54, v66 offset:64
  ds_write_b32 v54, v67 offset:96
  s_branch L_qjoinG
L_islowG:
  s_add_u32 s100, s100, 1
  s_cmp_gt_u32 s100, 200000
  s_cbranch_scc1 L_end
  v_mov_b32 v52, 0x80
  global_load_dwordx2 v[52:53], v52, s[60:61] sc1
  s_waitcnt vmcnt(0)
  v_readfirstlane_b32 s34, v52
  v_readfirstlane_b32 s35, v53
  s_nop 3
  s_branch L_ichkG
L_Gfar:
  buffer_store_dword v6, v89, s[28:31], s76 offen sc1
  s_branch L_Gdone
L_last:
.section .rodata,"a"
.p2align 6
.amdhsa_kernel sequential_preLN__sliding_block_cached__glu_gated_glu__decode_kernel
  .amdhsa_next_free_vgpr 512
  .amdhsa_next_free_sgpr 102
  .amdhsa_accum_offset 256
  .amdhsa_group_segment_fixed_size 0
  .amdhsa_kernarg_size 96
  .amdhsa_user_sgpr_count 2
  .amdhsa_user_sgpr_kernarg_segment_ptr 1
  .amdhsa_system_sgpr_workgroup_id_x 1
  .amdhsa_float_denorm_mode_32 3
.end_amdhsa_kernel
```
